```python
import torch

def _softmax(x, axis=-1):
    return torch.softmax(x, dim=axis)

def _gelu(x):
    return torch.nn.functional.gelu(x, approximate='tanh')

def _silu(x):
    return torch.nn.functional.silu(x)

def _sigmoid(x):
    return torch.sigmoid(x)

def _layernorm(x, axis=-1, eps=1e-05):
    m = x.mean(dim=axis, keepdim=True)
    v = x.var(dim=axis, keepdim=True, unbiased=False)
    return (x - m) / torch.sqrt(v + eps)

def _scatter_add(tgt, idx, src, axis=0):
    return tgt.clone().index_add_(axis, idx, src)

def _segment_sum(src, seg, n):
    out = torch.zeros((n,) + src.shape[1:], dtype=src.dtype)
    return out.index_add_(0, seg, src)

def _pad(x, pw):
    flat = tuple((v for pair in reversed(pw) for v in pair))
    return torch.nn.functional.pad(x, flat)
kernel_name = 'gather_scatter__tensor_product_equiv_mace__graph'

def setup_inputs():

    _w = lambda a: (lambda t: t.to(torch.bfloat16) if t.is_floating_point() else t)(torch.as_tensor(a))
    N, deg = (10000, 16)
    Lmax, C, De = (1, 128, 16)
    M = (Lmax + 1) ** 2
    E = N * deg
    src = (lambda lo, hi, *s: torch.randint(lo, hi, s))(0, N, E).to(torch.int64)
    dst = (lambda lo, hi, *s: torch.randint(lo, hi, s))(0, N, E).to(torch.int64)
    r = (lambda *s: torch.randn(*s, dtype=torch.bfloat16) * 0.05)(E, 3).to(float)
    r = r / (torch.linalg.norm(r, dim=-1, keepdim=True).to(float) + 1e-06)
    rx, ry, rz = (r[:, 0].clone(), r[:, 1].clone(), r[:, 2].clone())
    x2, y2, z2 = (rx * rx, ry * ry, rz * rz)
    sh_list = [torch.ones_like(rx), rx, ry, rz, rx * ry, ry * rz, 2.0 * z2 - x2 - y2, rx * rz, x2 - y2, ry * (3.0 * x2 - y2), rx * ry * rz, ry * (4.0 * z2 - x2 - y2), rz * (2.0 * z2 - 3.0 * x2 - 3.0 * y2), rx * (4.0 * z2 - x2 - y2), rz * (x2 - y2), rx * (x2 - 3.0 * y2)]
    sh16 = torch.stack(sh_list, dim=-1).to(float)
    pad = max(0, M - 16)
    sh_full = torch.cat([sh16, torch.zeros((E, pad), dtype=float)], dim=-1)[:, :M]
    cg = ((lambda *s: torch.randn(*s, dtype=torch.bfloat16) * 0.05)(M, M, M) * (1.0 / float(M))).to(float)
    return {'x': _w(((lambda *s: torch.randn(*s, dtype=torch.bfloat16) * 0.05)(N, M, C) * 0.3).to(float)), 'src': _w(src), 'dst': _w(dst), 'sh': _w(sh_full.to(float)), 'edge_attr': _w(((lambda *s: torch.randn(*s, dtype=torch.bfloat16) * 0.05)(E, De) * 0.3).to(float)), 'cg': _w(cg), 'w_r': _w(((lambda *s: torch.randn(*s, dtype=torch.bfloat16) * 0.05)(De, C) * (1.0 / float(De) ** 0.5)).to(float)), 'w_out': _w(((lambda *s: torch.randn(*s, dtype=torch.bfloat16) * 0.05)(C, C) * (1.0 / float(C) ** 0.5)).to(float))}

def reference(x, src, dst, sh, edge_attr, cg, w_r, w_out):
    N = x.shape[0]
    M = x.shape[1]
    C = x.shape[2]
    h = x[src]
    tp = torch.einsum('uvw,euc,ev->ewc', cg, h, sh)
    rw = edge_attr @ w_r
    msg = tp * rw[:, None, :]
    msg2 = msg.reshape(-1, M * C)
    agg = _segment_sum(msg2, dst, N).reshape(N, M, C)
    out = torch.einsum('nmc,cd->nmd', agg, w_out)
    return out
```

```asm
; @launch grid=(250,1,1) block=(512,1,1) lds=139520
.amdgcn_target "amdgcn-amd-amdhsa--gfx950"
.text
.globl gather_scatter__tensor_product_equiv_mace__graph_kernel
.p2align 8
.type gather_scatter__tensor_product_equiv_mace__graph_kernel,@function
gather_scatter__tensor_product_equiv_mace__graph_kernel:
    s_cmp_ge_u32 s2, 250
    s_cbranch_scc1 K2_END
    s_load_dwordx4 s[48:51], s[0:1], 8
    s_cmp_ge_u32 s2, 8
    s_cbranch_scc1 F_NOC
    s_getpc_b64 s[62:63]
F_PC:
    v_lshlrev_b32 v6, 7, v0
    v_cmp_gt_u32 vcc, K2_END-F_PC, v6
    s_and_saveexec_b64 s[64:65], vcc
    s_cbranch_execz F_NOC2
    global_load_dword v7, v6, s[62:63]
F_NOC2:
    s_mov_b64 exec, -1
F_NOC:
    s_sub_u32 s71, s2, 8
    s_load_dwordx2 s[16:17], s[0:1], 80
    s_load_dwordx2 s[52:53], s[0:1], 24
    s_load_dwordx4 s[56:59], s[0:1], 40
    s_load_dwordx2 s[60:61], s[0:1], 56
    s_load_dwordx2 s[4:5], s[0:1], 0
    s_load_dwordx2 s[8:9], s[0:1], 32
    s_load_dwordx2 s[12:13], s[0:1], 64
    v_lshrrev_b32 v52, 6, v0
    v_and_b32 v1, 63, v0
    v_readfirstlane_b32 s20, v52
    v_lshlrev_b32 v52, 2, v0
    v_mov_b32 v51, 0
    ds_write_b32 v52, v51 offset:0
    s_mul_i32 s3, s71, 1280
    v_add_lshl_u32 v49, s3, v52, 2
    s_cmp_lt_u32 s71, 125
    s_cselect_b32 s25, 5, 0
    s_cmp_ge_u32 s20, s25
    s_waitcnt lgkmcnt(0)
    s_cbranch_scc1 F_B1
    global_load_dwordx4 v[56:59], v49, s[50:51]
F_B1:
    s_load_dwordx2 s[76:77], s[16:17], 520192
    v_lshlrev_b32 v50, 1, v49
    s_barrier
    s_cbranch_scc1 F_L
    global_load_dwordx4 v[60:63], v49, s[48:49]
    global_load_dwordx4 v[208:211], v50, s[52:53]
    global_load_dwordx4 v[212:215], v50, s[52:53] offset:16
F_L:
    v_min_u32 v52, 1276, v52
    ds_write_b32 v52, v51 offset:48640
    v_add_u32 v53, 1, v1
    v_cmp_gt_u32 vcc, 40, v1
    v_lshlrev_b32 v52, 2, v1
    v_lshlrev_b32 v1, 4, v1
    v_cndmask_b32 v53, 0, v53, vcc
    ds_write_b32 v52, v53 offset:49920
    v_mov_b32 v51, 1
    s_mov_b32 s21, 0
    s_mov_b32 s72, 1
    s_mov_b32 s18, 268435456
    s_mov_b32 s19, 0x20000
    s_cmp_lt_u32 s20, 5
    s_cbranch_scc1 F_NOW
    v_and_b32 v154, 0xf0, v1
    v_lshrrev_b32 v155, 8, v1
    s_mov_b32 s64, 0x05040100
    s_mov_b32 s65, 0x07060302
    s_cmp_eq_u32 s20, 5
    s_cbranch_scc1 F_W5
    s_and_b32 s27, s20, 1
    s_lshl_b32 s23, s27, 9
    v_lshl_add_u32 v156, v155, 13, v154
    v_add_u32 v156, s23, v156
    v_add_u32 v157, 4096, v156
    global_load_dwordx4 v[192:195], v156, s[60:61] offset:0
    global_load_dwordx4 v[196:199], v156, s[60:61] offset:1024
    global_load_dwordx4 v[200:203], v156, s[60:61] offset:2048
    global_load_dwordx4 v[204:207], v156, s[60:61] offset:3072
    global_load_dwordx4 v[208:211], v157, s[60:61] offset:0
    global_load_dwordx4 v[212:215], v157, s[60:61] offset:1024
    global_load_dwordx4 v[216:219], v157, s[60:61] offset:2048
    global_load_dwordx4 v[220:223], v157, s[60:61] offset:3072
    global_load_dwordx4 v[224:227], v156, s[60:61] offset:256
    global_load_dwordx4 v[228:231], v156, s[60:61] offset:1280
    global_load_dwordx4 v[232:235], v156, s[60:61] offset:2304
    global_load_dwordx4 v[236:239], v156, s[60:61] offset:3328
    global_load_dwordx4 v[240:243], v157, s[60:61] offset:256
    global_load_dwordx4 v[244:247], v157, s[60:61] offset:1280
    global_load_dwordx4 v[248:251], v157, s[60:61] offset:2304
    global_load_dwordx4 v[252:255], v157, s[60:61] offset:3328
    s_lshl_b32 s22, s27, 13
    s_add_u32 s22, s22, 52224
    v_bfe_u32 v156, v1, 7, 1
    v_mul_u32_u24 v156, 16400, v156
    v_lshl_add_u32 v156, v155, 8, v156
    v_and_b32 v154, 0x70, v1
    v_lshl_add_u32 v156, v154, 1, v156
    v_add_u32 v156, s22, v156
    s_branch F_NOW
F_W5:
    v_and_b32 v157, 1, v155
    v_lshl_add_u32 v156, v157, 11, v154
    v_bfe_u32 v158, v1, 4, 2
    v_lshlrev_b32 v158, 1, v158
    v_lshl_add_u32 v158, v155, 5, v158
    global_load_dwordx4 v[224:227], v156, s[58:59] offset:0
    global_load_dwordx4 v[228:231], v156, s[58:59] offset:256
    global_load_dwordx4 v[232:235], v156, s[58:59] offset:512
    global_load_dwordx4 v[236:239], v156, s[58:59] offset:768
    global_load_dwordx4 v[240:243], v156, s[58:59] offset:1024
    global_load_dwordx4 v[244:247], v156, s[58:59] offset:1280
    global_load_dwordx4 v[248:251], v156, s[58:59] offset:1536
    global_load_dwordx4 v[252:255], v156, s[58:59] offset:1792
    global_load_ushort v96, v158, s[56:57] offset:0
    global_load_ushort v97, v158, s[56:57] offset:8
    global_load_ushort v98, v158, s[56:57] offset:16
    global_load_ushort v99, v158, s[56:57] offset:24
    v_lshl_add_u32 v156, v157, 9, v154
F_NOW:
    s_cmp_ge_u32 s20, s25
    s_cbranch_scc1 F_B2
    s_waitcnt vmcnt(3)
    v_mul_u32_u24 v64, 0xcccd, v56
    v_lshrrev_b32 v64, 21, v64
    v_lshlrev_b32 v68, 7, v64
    v_and_b32 v68, 0x380, v68
    v_lshrrev_b32 v52, 3, v64
    v_lshl_or_b32 v68, v52, 2, v68
    ds_add_rtn_u32 v72, v68, v51 offset:0
    v_mul_u32_u24 v65, 0xcccd, v57
    v_lshrrev_b32 v65, 21, v65
    v_lshlrev_b32 v69, 7, v65
    v_and_b32 v69, 0x380, v69
    v_lshrrev_b32 v52, 3, v65
    v_lshl_or_b32 v69, v52, 2, v69
    ds_add_rtn_u32 v73, v69, v51 offset:0
    v_mul_u32_u24 v66, 0xcccd, v58
    v_lshrrev_b32 v66, 21, v66
    v_lshlrev_b32 v70, 7, v66
    v_and_b32 v70, 0x380, v70
    v_lshrrev_b32 v52, 3, v66
    v_lshl_or_b32 v70, v52, 2, v70
    ds_add_rtn_u32 v74, v70, v51 offset:0
    v_mul_u32_u24 v67, 0xcccd, v59
    v_lshrrev_b32 v67, 21, v67
    v_lshlrev_b32 v71, 7, v67
    v_and_b32 v71, 0x380, v71
    v_lshrrev_b32 v52, 3, v67
    v_lshl_or_b32 v71, v52, 2, v71
    ds_add_rtn_u32 v75, v71, v51 offset:0
    v_mul_u32_u24 v52, 40, v64
    v_sub_u32 v56, v56, v52
    v_mul_u32_u24 v52, 40, v65
    v_sub_u32 v57, v57, v52
    v_mul_u32_u24 v52, 40, v66
    v_sub_u32 v58, v58, v52
    v_mul_u32_u24 v52, 40, v67
    v_sub_u32 v59, v59, v52
F_B2:
    v_lshrrev_b32 v54, 1, v1
    s_waitcnt lgkmcnt(0)
    s_barrier
    s_cmp_eq_u32 s20, 5
    s_cbranch_scc1 F_P5
    ds_read_b128 v[80:83], v1 offset:0
    s_add_u32 s76, s76, 0x9e3779b1
    s_and_b32 s77, s77, 0xffc00000
    s_lshl_b32 s79, s76, 11
    s_and_b32 s78, s76, 0xff000303
    s_cmp_ge_u32 s71, 125
    s_cbranch_scc1 F_IDLE
    s_cmp_ge_u32 s20, 6
    s_cbranch_scc1 F_B3
    s_waitcnt lgkmcnt(0)
    v_add3_u32 v52, v80, v81, v82
    v_add_u32 v52, v52, v83
    v_mov_b32 v53, v52
    s_nop 1
    v_add_u32_dpp v53, v53, v53 row_shr:1 row_mask:0xf bank_mask:0xf
    s_nop 1
    v_add_u32_dpp v53, v53, v53 row_shr:2 row_mask:0xf bank_mask:0xf
    s_nop 1
    v_add_u32_dpp v53, v53, v53 row_shr:4 row_mask:0xf bank_mask:0xf
    s_nop 1
    v_add_u32_dpp v53, v53, v53 row_shr:8 row_mask:0xf bank_mask:0xf
    s_nop 1
    v_add_u32_dpp v53, v53, v53 row_bcast:15 row_mask:0xa bank_mask:0xf
    s_nop 1
    v_add_u32_dpp v53, v53, v53 row_bcast:31 row_mask:0xc bank_mask:0xf
    v_sub_u32 v53, v53, v52
    v_lshl_or_b32 v84, v80, 11, v53
    v_add_u32 v53, v53, v80
    v_lshl_or_b32 v85, v81, 11, v53
    v_add_u32 v53, v53, v81
    v_lshl_or_b32 v86, v82, 11, v53
    v_add_u32 v53, v53, v82
    v_lshl_or_b32 v87, v83, 11, v53
    ds_write_b128 v1, v[84:87] offset:2048
    s_branch F_BIN
F_P5:
    ds_read2_b64 v[80:83], v54 offset0:0 offset1:64
    s_add_u32 s76, s76, 0x9e3779b1
    s_and_b32 s77, s77, 0xffc00000
    s_lshl_b32 s79, s76, 11
    s_and_b32 s78, s76, 0xff000303
    s_cmp_ge_u32 s71, 125
    s_cbranch_scc1 F_IDLE
    s_lshl_b32 s26, s71, 11
    v_mov_b32 v209, s76
    v_mov_b32 v211, s76
    v_mov_b32 v213, s76
    v_mov_b32 v215, s76
    s_waitcnt lgkmcnt(0)
    v_add_u32 v52, v80, v81
    v_add_u32 v53, v82, v83
    v_lshl_or_b32 v52, v53, 16, v52
    v_mov_b32 v53, v52
    v_lshl_or_b32 v84, v80, 11, s77
    v_lshl_or_b32 v85, v81, 11, s77
    v_lshl_or_b32 v86, v82, 11, s77
    v_lshl_or_b32 v87, v83, 11, s77
    s_nop 1
    v_add_u32_dpp v53, v53, v53 row_shr:1 row_mask:0xf bank_mask:0xf
    s_nop 1
    v_add_u32_dpp v53, v53, v53 row_shr:2 row_mask:0xf bank_mask:0xf
    s_nop 1
    v_add_u32_dpp v53, v53, v53 row_shr:4 row_mask:0xf bank_mask:0xf
    s_nop 1
    v_add_u32_dpp v53, v53, v53 row_shr:8 row_mask:0xf bank_mask:0xf
    s_nop 1
    v_add_u32_dpp v53, v53, v53 row_bcast:15 row_mask:0xa bank_mask:0xf
    s_nop 1
    v_add_u32_dpp v53, v53, v53 row_bcast:31 row_mask:0xc bank_mask:0xf
    v_sub_u32 v52, v53, v52
    v_readlane_b32 s27, v53, 63
    v_and_b32 v53, 0xffff, v52
    v_lshrrev_b32 v52, 16, v52
    s_and_b32 s27, s27, 0xffff
    v_or_b32 v208, v84, v53
    v_add3_u32 v210, v85, v53, v80
    v_add_u32 v52, s27, v52
    v_or_b32 v212, v86, v52
    v_add3_u32 v214, v87, v52, v82
    buffer_store_dwordx4 v[208:211], v1, s[16:19], s26 offen sc1
    buffer_store_dwordx4 v[212:215], v1, s[16:19], s26 offen offset:1024 sc1
    s_barrier
    s_waitcnt vmcnt(2)
F_W5T:
    v_perm_b32 v144, v228, v224, s64
    v_perm_b32 v145, v236, v232, s64
    v_perm_b32 v146, v244, v240, s64
    v_perm_b32 v147, v252, v248, s64
    ds_write_b128 v156, v[144:147] offset:43520
    v_perm_b32 v148, v228, v224, s65
    v_perm_b32 v149, v236, v232, s65
    v_perm_b32 v150, v244, v240, s65
    v_perm_b32 v151, v252, v248, s65
    ds_write_b128 v156, v[148:151] offset:43776
    v_perm_b32 v144, v229, v225, s64
    v_perm_b32 v145, v237, v233, s64
    v_perm_b32 v146, v245, v241, s64
    v_perm_b32 v147, v253, v249, s64
    ds_write_b128 v156, v[144:147] offset:44544
    v_perm_b32 v148, v229, v225, s65
    v_perm_b32 v149, v237, v233, s65
    v_perm_b32 v150, v245, v241, s65
    v_perm_b32 v151, v253, v249, s65
    ds_write_b128 v156, v[148:151] offset:44800
    v_perm_b32 v144, v230, v226, s64
    v_perm_b32 v145, v238, v234, s64
    v_perm_b32 v146, v246, v242, s64
    v_perm_b32 v147, v254, v250, s64
    ds_write_b128 v156, v[144:147] offset:45568
    v_perm_b32 v148, v230, v226, s65
    v_perm_b32 v149, v238, v234, s65
    v_perm_b32 v150, v246, v242, s65
    v_perm_b32 v151, v254, v250, s65
    ds_write_b128 v156, v[148:151] offset:45824
    v_perm_b32 v144, v231, v227, s64
    v_perm_b32 v145, v239, v235, s64
    v_perm_b32 v146, v247, v243, s64
    v_perm_b32 v147, v255, v251, s64
    ds_write_b128 v156, v[144:147] offset:46592
    v_perm_b32 v148, v231, v227, s65
    v_perm_b32 v149, v239, v235, s65
    v_perm_b32 v150, v247, v243, s65
    v_perm_b32 v151, v255, v251, s65
    ds_write_b128 v156, v[148:151] offset:46848
    v_and_b32 v154, 64, v1
    v_cmp_eq_u32 vcc, 0, v154
    v_lshl_or_b32 v96, v97, 16, v96
    v_lshl_or_b32 v98, v99, 16, v98
    v_cndmask_b32 v176, 0, v96, vcc
    v_cndmask_b32 v177, 0, v98, vcc
    v_sub_u32 v178, v96, v176
    v_sub_u32 v179, v98, v177
    ds_write_b128 v1, v[176:179] offset:47616
    s_branch K2_GO
F_BIN:
    ds_read_b32 v76, v68 offset:2048
    ds_read_b32 v77, v69 offset:2048
    ds_read_b32 v78, v70 offset:2048
    ds_read_b32 v79, v71 offset:2048
    v_lshl_or_b32 v53, v0, 2, s79
    s_waitcnt vmcnt(2)
    v_lshl_or_b32 v52, v56, 2, s78
    v_lshl_or_b32 v192, v60, 10, v52
    v_or_b32 v194, 0, v53
    v_lshl_or_b32 v52, v57, 2, s78
    v_lshl_or_b32 v196, v61, 10, v52
    v_or_b32 v198, 1, v53
    v_lshl_or_b32 v52, v58, 2, s78
    v_lshl_or_b32 v200, v62, 10, v52
    v_or_b32 v202, 2, v53
    v_lshl_or_b32 v52, v59, 2, s78
    v_lshl_or_b32 v204, v63, 10, v52
    v_or_b32 v206, 3, v53
    s_waitcnt lgkmcnt(0)
    v_and_b32 v76, 0x7ff, v76
    v_add_lshl_u32 v76, v76, v72, 4
    v_and_b32 v77, 0x7ff, v77
    v_add_lshl_u32 v77, v77, v73, 4
    v_and_b32 v78, 0x7ff, v78
    v_add_lshl_u32 v78, v78, v74, 4
    v_and_b32 v79, 0x7ff, v79
    v_add_lshl_u32 v79, v79, v75, 4
    s_waitcnt vmcnt(0)
    v_mov_b32 v193, v208
    v_mov_b32 v195, v209
    ds_write_b128 v76, v[192:195] offset:3072
    v_mov_b32 v197, v210
    v_mov_b32 v199, v211
    ds_write_b128 v77, v[196:199] offset:3072
    v_mov_b32 v201, v212
    v_mov_b32 v203, v213
    ds_write_b128 v78, v[200:203] offset:3072
    v_mov_b32 v205, v214
    v_mov_b32 v207, v215
    ds_write_b128 v79, v[204:207] offset:3072
    s_lshl_b32 s27, s20, 12
    v_add_u32 v52, s27, v1
    s_mul_i32 s26, s71, 20480
    s_add_u32 s26, s26, 524288
    s_waitcnt lgkmcnt(0)
    s_barrier
    ds_read_b128 v[192:195], v52 offset:3072
    ds_read_b128 v[196:199], v52 offset:4096
    ds_read_b128 v[200:203], v52 offset:5120
    ds_read_b128 v[204:207], v52 offset:6144
    s_waitcnt lgkmcnt(3)
    buffer_store_dwordx4 v[192:195], v52, s[16:19], s26 offen offset:0 sc1
    s_waitcnt lgkmcnt(2)
    buffer_store_dwordx4 v[196:199], v52, s[16:19], s26 offen offset:1024 sc1
    s_waitcnt lgkmcnt(1)
    buffer_store_dwordx4 v[200:203], v52, s[16:19], s26 offen offset:2048 sc1
    s_waitcnt lgkmcnt(0)
    buffer_store_dwordx4 v[204:207], v52, s[16:19], s26 offen offset:3072 sc1
    s_branch K2_GO
F_B3:
    s_barrier
F_WOT:
    s_waitcnt vmcnt(8)
    v_perm_b32 v144, v196, v192, s64
    v_perm_b32 v145, v204, v200, s64
    v_perm_b32 v146, v212, v208, s64
    v_perm_b32 v147, v220, v216, s64
    ds_write_b128 v156, v[144:147] offset:0
    v_perm_b32 v148, v196, v192, s65
    v_perm_b32 v149, v204, v200, s65
    v_perm_b32 v150, v212, v208, s65
    v_perm_b32 v151, v220, v216, s65
    ds_write_b128 v156, v[148:151] offset:1024
    v_perm_b32 v144, v197, v193, s64
    v_perm_b32 v145, v205, v201, s64
    v_perm_b32 v146, v213, v209, s64
    v_perm_b32 v147, v221, v217, s64
    ds_write_b128 v156, v[144:147] offset:2048
    v_perm_b32 v148, v197, v193, s65
    v_perm_b32 v149, v205, v201, s65
    v_perm_b32 v150, v213, v209, s65
    v_perm_b32 v151, v221, v217, s65
    ds_write_b128 v156, v[148:151] offset:3072
    v_perm_b32 v144, v198, v194, s64
    v_perm_b32 v145, v206, v202, s64
    v_perm_b32 v146, v214, v210, s64
    v_perm_b32 v147, v222, v218, s64
    ds_write_b128 v156, v[144:147] offset:16
    v_perm_b32 v148, v198, v194, s65
    v_perm_b32 v149, v206, v202, s65
    v_perm_b32 v150, v214, v210, s65
    v_perm_b32 v151, v222, v218, s65
    ds_write_b128 v156, v[148:151] offset:1040
    v_perm_b32 v144, v199, v195, s64
    v_perm_b32 v145, v207, v203, s64
    v_perm_b32 v146, v215, v211, s64
    v_perm_b32 v147, v223, v219, s64
    ds_write_b128 v156, v[144:147] offset:2064
    v_perm_b32 v148, v199, v195, s65
    v_perm_b32 v149, v207, v203, s65
    v_perm_b32 v150, v215, v211, s65
    v_perm_b32 v151, v223, v219, s65
    ds_write_b128 v156, v[148:151] offset:3088
    s_waitcnt vmcnt(0)
    v_perm_b32 v144, v228, v224, s64
    v_perm_b32 v145, v236, v232, s64
    v_perm_b32 v146, v244, v240, s64
    v_perm_b32 v147, v252, v248, s64
    ds_write_b128 v156, v[144:147] offset:4096
    v_perm_b32 v148, v228, v224, s65
    v_perm_b32 v149, v236, v232, s65
    v_perm_b32 v150, v244, v240, s65
    v_perm_b32 v151, v252, v248, s65
    ds_write_b128 v156, v[148:151] offset:5120
    v_perm_b32 v144, v229, v225, s64
    v_perm_b32 v145, v237, v233, s64
    v_perm_b32 v146, v245, v241, s64
    v_perm_b32 v147, v253, v249, s64
    ds_write_b128 v156, v[144:147] offset:6144
    v_perm_b32 v148, v229, v225, s65
    v_perm_b32 v149, v237, v233, s65
    v_perm_b32 v150, v245, v241, s65
    v_perm_b32 v151, v253, v249, s65
    ds_write_b128 v156, v[148:151] offset:7168
    v_perm_b32 v144, v230, v226, s64
    v_perm_b32 v145, v238, v234, s64
    v_perm_b32 v146, v246, v242, s64
    v_perm_b32 v147, v254, v250, s64
    ds_write_b128 v156, v[144:147] offset:4112
    v_perm_b32 v148, v230, v226, s65
    v_perm_b32 v149, v238, v234, s65
    v_perm_b32 v150, v246, v242, s65
    v_perm_b32 v151, v254, v250, s65
    ds_write_b128 v156, v[148:151] offset:5136
    v_perm_b32 v144, v231, v227, s64
    v_perm_b32 v145, v239, v235, s64
    v_perm_b32 v146, v247, v243, s64
    v_perm_b32 v147, v255, v251, s64
    ds_write_b128 v156, v[144:147] offset:6160
    v_perm_b32 v148, v231, v227, s65
    v_perm_b32 v149, v239, v235, s65
    v_perm_b32 v150, v247, v243, s65
    v_perm_b32 v151, v255, v251, s65
    ds_write_b128 v156, v[148:151] offset:7184
    s_branch K2_GO
F_IDLE:
    s_cmp_ge_u32 s20, 6
    s_cbranch_scc1 F_WOT
    s_waitcnt vmcnt(0)
    s_cmp_eq_u32 s20, 5
    s_cbranch_scc1 F_W5T
    s_cmp_lg_u32 s20, 0
    s_cbranch_scc1 K2_GO
    s_sub_u32 s26, s2, 125
    s_min_u32 s26, s26, s2
    s_lshl_b32 s26, s26, 7
    s_add_u32 s26, s26, 393216
    v_mov_b32 v52, s76
    v_mov_b32 v53, s77
    s_mov_b64 exec, 1
    buffer_store_dwordx2 v[52:53], v1, s[16:19], s26 offen sc1
    s_mov_b64 exec, -1
    s_branch K2_GO
K2_ROUND:
    v_min_u32 v72, 319, v0
    v_lshlrev_b32 v72, 2, v72
    v_mov_b32 v73, 0
    ds_write_b32 v72, v73 offset:48640
K2_GO:
    v_lshrrev_b32 v77, 2, v0
    v_lshlrev_b32 v146, 11, v77
    v_cmp_gt_u32 vcc, 125, v77
    s_and_b32 s26, s2, 7
    s_lshl_b32 s26, s26, 8
    s_and_b32 s27, s2, 0xf8
    s_add_u32 s26, s26, s27
    v_mov_b32 v144, 0
    s_mov_b64 s[56:57], vcc
    s_cmp_lt_u32 s71, 125
    s_cbranch_scc1 K2_FULL
    s_mov_b32 s27, 0
    s_mov_b64 exec, 1
K2_PRE:
    buffer_load_dword v145, v146, s[16:19], s26 offen offset:4 sc1
    s_add_u32 s27, s27, 1
    s_waitcnt vmcnt(0)
    v_readfirstlane_b32 s22, v145
    s_cmp_eq_u32 s22, s76
    s_cbranch_scc1 K2_FULL
    s_cmp_lt_u32 s27, 400000
    s_cbranch_scc1 K2_PRE
K2_FULL:
    s_mov_b64 exec, vcc
    buffer_load_dwordx2 v[144:145], v146, s[16:19], s26 offen sc1
    s_mov_b64 exec, -1
    v_mul_u32_u24 v149, 1280, v77
    v_and_b32 v78, 3, v0
    v_add_u32 v78, s21, v78
    v_add_u32 v77, v149, v78
    v_mov_b32 v73, 1
    v_mov_b32 v100, 0x7ff00000
    v_mov_b32 v105, 0x10000000
    v_mov_b32 v101, 0x7ff00000
    v_mov_b32 v106, 0x10000000
    v_mov_b32 v102, 0x7ff00000
    v_mov_b32 v107, 0x10000000
    v_mov_b32 v103, 0x7ff00000
    v_mov_b32 v108, 0x10000000
    v_mov_b32 v104, 0x7ff00000
    v_mov_b32 v109, 0x10000000
    v_and_b32 v110, 16, v1
    v_add_u32 v111, 4294812544, v110
    v_mov_b32 v74, 64
    v_lshrrev_b32 v75, 2, v1
    s_cmp_eq_u32 s72, 0
    s_cbranch_scc1 K2_NOW
    s_mov_b32 s6, 10240000
    s_mov_b32 s7, 0x20000
    s_mov_b32 s10, 5120000
    s_mov_b32 s11, 0x20000
    s_mov_b32 s14, 10240000
    s_mov_b32 s15, 0x20000
    v_mov_b64 v[8:9], 0
    v_mov_b64 v[10:11], 0
    v_mov_b64 v[12:13], 0
    v_mov_b64 v[14:15], 0
    v_mov_b64 v[16:17], 0
    v_mov_b64 v[18:19], 0
    v_mov_b64 v[20:21], 0
    v_mov_b64 v[22:23], 0
    v_mov_b64 v[24:25], 0
    v_mov_b64 v[26:27], 0
    v_mov_b64 v[28:29], 0
    v_mov_b64 v[30:31], 0
    v_mov_b64 v[32:33], 0
    v_mov_b64 v[34:35], 0
    v_mov_b64 v[36:37], 0
    v_mov_b64 v[38:39], 0
    v_mov_b64 v[40:41], 0
    v_mov_b64 v[42:43], 0
    v_mov_b64 v[44:45], 0
    v_mov_b64 v[46:47], 0
    v_mov_b64 v[112:113], 0
    v_mov_b64 v[114:115], 0
    v_mov_b64 v[116:117], 0
    v_mov_b64 v[118:119], 0
    v_mov_b64 v[120:121], 0
    v_mov_b64 v[122:123], 0
    v_mov_b64 v[124:125], 0
    v_mov_b64 v[126:127], 0
    v_mov_b64 v[128:129], 0
    v_mov_b64 v[130:131], 0
    v_mov_b64 v[132:133], 0
    v_mov_b64 v[134:135], 0
    v_mov_b64 v[136:137], 0
    v_mov_b64 v[138:139], 0
    v_mov_b64 v[140:141], 0
    v_mov_b64 v[142:143], 0
    v_mov_b64 v[180:181], 0
    v_mov_b64 v[182:183], 0
    v_mov_b64 v[184:185], 0
    v_mov_b64 v[186:187], 0
    v_mov_b64 v[188:189], 0
    s_mov_b32 s28, 0xf0f0f0f
    s_mov_b32 s29, 0xf0f0f0f
    s_mov_b32 s30, 0xf0f0f0f0
    s_mov_b32 s31, 0xf0f0f0f0
    s_mov_b32 s32, 0xf0f0f0f
    s_mov_b32 s33, 0xf0f0f0f0
    s_mov_b32 s34, 0xff00ff
    s_mov_b32 s35, 0xff00ff
    s_mov_b32 s36, 0xff00ff00
    s_mov_b32 s37, 0xff00ff00
    s_mul_i32 s40, s20, 5
    s_add_u32 s41, s40, 1
    s_add_u32 s42, s40, 2
    s_add_u32 s43, s40, 3
    s_add_u32 s44, s40, 4
K2_NOW:
    s_mov_b32 s27, 0
    s_mov_b64 exec, s[56:57]
K2_POLL:
    s_waitcnt vmcnt(0)
    v_xor_b32 v147, s77, v144
    v_xor_b32 v148, s76, v145
    v_lshrrev_b32 v147, 22, v147
    v_or_b32 v147, v147, v148
    v_cmp_ne_u32 vcc, 0, v147
    s_and_b64 exec, exec, vcc
    s_cbranch_execz K2_POLLED
    buffer_load_dwordx2 v[144:145], v146, s[16:19], s26 offen sc1
    s_add_u32 s27, s27, 1
    s_cmp_lt_u32 s27, 400000
    s_cbranch_scc1 K2_POLL
    s_waitcnt vmcnt(0)
    v_mov_b32 v144, 0
K2_POLLED:
    s_mov_b64 exec, -1
    s_mov_b32 s27, 524288
    v_and_b32 v79, 0x7ff, v144
    v_add_lshl_u32 v77, v77, v79, 4
    v_bfe_u32 v76, v144, 11, 11
    v_sub_u32 v76, v76, v78
    v_cmp_lt_i32 s[56:57], 0, v76
    v_cmp_lt_i32 s[58:59], 4, v76
    v_cmp_lt_i32 s[60:61], 8, v76
    v_cmp_lt_i32 s[62:63], 12, v76
    v_cmp_lt_i32 s[64:65], 16, v76
    s_mov_b32 s73, 20
    s_mov_b64 exec, s[56:57]
    s_cbranch_execz K2_LOADED
    buffer_load_dwordx4 v[80:83], v77, s[16:19], s27 offen offset:0 sc1
    s_mov_b64 exec, s[58:59]
    s_cbranch_execz K2_LOADED
    buffer_load_dwordx4 v[84:87], v77, s[16:19], s27 offen offset:64 sc1
    s_bcnt1_i32_b64 s26, s[56:57]
    s_bcnt1_i32_b64 s24, s[58:59]
    s_add_u32 s26, s26, s24
    s_bcnt1_i32_b64 s24, s[60:61]
    s_add_u32 s26, s26, s24
    s_bcnt1_i32_b64 s24, s[62:63]
    s_add_u32 s26, s26, s24
    s_bcnt1_i32_b64 s24, s[64:65]
    s_add_u32 s26, s26, s24
    s_cmp_le_u32 s26, 128
    s_cbranch_scc1 K2_QOK
    s_mov_b64 s[60:61], 0
    s_mov_b64 s[62:63], 0
    s_mov_b64 s[64:65], 0
    s_mov_b32 s73, 8
K2_QOK:
    s_mov_b64 exec, s[60:61]
    s_cbranch_execz K2_LOADED
    buffer_load_dwordx4 v[88:91], v77, s[16:19], s27 offen offset:128 sc1
    s_mov_b64 exec, s[62:63]
    s_cbranch_execz K2_LOADED
    buffer_load_dwordx4 v[92:95], v77, s[16:19], s27 offen offset:192 sc1
    s_mov_b64 exec, s[64:65]
    s_cbranch_execz K2_LOADED
    buffer_load_dwordx4 v[96:99], v77, s[16:19], s27 offen offset:256 sc1
K2_LOADED:
    s_mov_b64 exec, -1
    v_cmp_lt_i32 s[74:75], s73, v76
    s_add_u32 s21, s21, s73
    s_mov_b32 s22, 0
    s_mov_b32 s23, 0xff000303
    s_waitcnt lgkmcnt(0)
    s_barrier
K2_CHECK:
    v_mov_b32 v147, 0
    s_waitcnt vmcnt(0)
    s_mov_b64 exec, s[56:57]
    s_cbranch_execz K2_CHECKED
    v_xor_b32 v148, s78, v80
    v_xor_b32 v100, s79, v82
    v_and_or_b32 v147, v148, s23, v147
    v_lshrrev_b32 v148, 11, v100
    v_or_b32 v147, v147, v148
    v_add_lshl_u32 v100, v100, v149, 5
    s_mov_b64 exec, s[58:59]
    s_cbranch_execz K2_CHECKED
    v_xor_b32 v148, s78, v84
    v_xor_b32 v101, s79, v86
    v_and_or_b32 v147, v148, s23, v147
    v_lshrrev_b32 v148, 11, v101
    v_or_b32 v147, v147, v148
    v_add_lshl_u32 v101, v101, v149, 5
    s_mov_b64 exec, s[60:61]
    s_cbranch_execz K2_CHECKED
    v_xor_b32 v148, s78, v88
    v_xor_b32 v102, s79, v90
    v_and_or_b32 v147, v148, s23, v147
    v_lshrrev_b32 v148, 11, v102
    v_or_b32 v147, v147, v148
    v_add_lshl_u32 v102, v102, v149, 5
    s_mov_b64 exec, s[62:63]
    s_cbranch_execz K2_CHECKED
    v_xor_b32 v148, s78, v92
    v_xor_b32 v103, s79, v94
    v_and_or_b32 v147, v148, s23, v147
    v_lshrrev_b32 v148, 11, v103
    v_or_b32 v147, v147, v148
    v_add_lshl_u32 v103, v103, v149, 5
    s_mov_b64 exec, s[64:65]
    s_cbranch_execz K2_CHECKED
    v_xor_b32 v148, s78, v96
    v_xor_b32 v104, s79, v98
    v_and_or_b32 v147, v148, s23, v147
    v_lshrrev_b32 v148, 11, v104
    v_or_b32 v147, v147, v148
    v_add_lshl_u32 v104, v104, v149, 5
K2_CHECKED:
    s_mov_b64 exec, -1
    v_cmp_ne_u32 vcc, 0, v147
    s_add_u32 s22, s22, 1
    s_cmp_eq_u64 vcc, 0
    s_cbranch_scc1 K2_VALID
    s_cmp_ge_u32 s22, 400000
    s_cbranch_scc1 K2_GIVEUP
    s_mov_b64 s[38:39], vcc
    s_and_b64 exec, s[56:57], s[38:39]
    s_cbranch_execz K2_RELOADED
    buffer_load_dwordx4 v[80:83], v77, s[16:19], s27 offen offset:0 sc1
    s_and_b64 exec, s[58:59], s[38:39]
    s_cbranch_execz K2_RELOADED
    buffer_load_dwordx4 v[84:87], v77, s[16:19], s27 offen offset:64 sc1
    s_and_b64 exec, s[60:61], s[38:39]
    s_cbranch_execz K2_RELOADED
    buffer_load_dwordx4 v[88:91], v77, s[16:19], s27 offen offset:128 sc1
    s_and_b64 exec, s[62:63], s[38:39]
    s_cbranch_execz K2_RELOADED
    buffer_load_dwordx4 v[92:95], v77, s[16:19], s27 offen offset:192 sc1
    s_and_b64 exec, s[64:65], s[38:39]
    s_cbranch_execz K2_RELOADED
    buffer_load_dwordx4 v[96:99], v77, s[16:19], s27 offen offset:256 sc1
K2_RELOADED:
    s_mov_b64 exec, -1
    s_branch K2_CHECK
K2_GIVEUP:
    s_andn2_b64 s[56:57], s[56:57], vcc
    s_andn2_b64 s[58:59], s[58:59], vcc
    s_andn2_b64 s[60:61], s[60:61], vcc
    s_andn2_b64 s[62:63], s[62:63], vcc
    s_andn2_b64 s[64:65], s[64:65], vcc
K2_VALID:
    v_mov_b32 v72, 0
    s_mov_b64 exec, s[74:75]
    s_cbranch_execz K2_NOMORE
    ds_write_b32 v72, v73 offset:49664
K2_NOMORE:
    s_mov_b64 exec, s[56:57]
    s_cbranch_execz K2_DEGD
    v_and_b32 v56, 0xfc, v80
    ds_add_u32 v56, v74 offset:49920
    s_mov_b64 exec, s[58:59]
    s_cbranch_execz K2_DEGD
    v_and_b32 v57, 0xfc, v84
    ds_add_u32 v57, v74 offset:49920
    s_mov_b64 exec, s[60:61]
    s_cbranch_execz K2_DEGD
    v_and_b32 v58, 0xfc, v88
    ds_add_u32 v58, v74 offset:49920
    s_mov_b64 exec, s[62:63]
    s_cbranch_execz K2_DEGD
    v_and_b32 v59, 0xfc, v92
    ds_add_u32 v59, v74 offset:49920
    s_mov_b64 exec, s[64:65]
    s_cbranch_execz K2_DEGD
    v_and_b32 v60, 0xfc, v96
    ds_add_u32 v60, v74 offset:49920
K2_DEGD:
    s_mov_b64 exec, -1
    v_add_u32_dpp v152, v100, v110 quad_perm:[0,0,2,2] row_mask:0xf bank_mask:0xf
    buffer_load_dwordx4 v[216:219], v152, s[8:11], 0 offen
    v_add_u32_dpp v153, v100, v110 quad_perm:[1,1,3,3] row_mask:0xf bank_mask:0xf
    buffer_load_dwordx4 v[220:223], v153, s[8:11], 0 offen
    s_cmp_eq_u32 s72, 0
    s_cbranch_scc1 K2_MAPPED
    s_mov_b32 s72, 0
    s_waitcnt lgkmcnt(0)
    s_barrier
    ds_read_b32 v74, v75 offset:49920
    v_lshrrev_b32 v76, 4, v1
    v_add_u32 v76, s40, v76
    s_waitcnt lgkmcnt(0)
    v_readlane_b32 s45, v74, s40
    v_readlane_b32 s46, v74, s41
    v_readlane_b32 s47, v74, s42
    v_readlane_b32 s48, v74, s43
    v_readlane_b32 s49, v74, s44
    v_cmp_lt_u32 s[50:51], s45, v74
    v_cmp_lt_u32 s[52:53], s46, v74
    v_cmp_lt_u32 s[54:55], s47, v74
    s_bcnt1_i32_b64 s45, s[50:51]
    v_cmp_lt_u32 s[50:51], s48, v74
    s_bcnt1_i32_b64 s46, s[52:53]
    v_cmp_lt_u32 s[52:53], s49, v74
    s_bcnt1_i32_b64 s47, s[54:55]
    s_bcnt1_i32_b64 s48, s[50:51]
    s_bcnt1_i32_b64 s49, s[52:53]
    v_writelane_b32 v77, s45, 0
    v_writelane_b32 v77, s46, 1
    v_writelane_b32 v77, s47, 2
    v_writelane_b32 v77, s48, 3
    v_writelane_b32 v77, s49, 4
    s_mov_b64 exec, 31
    v_bfe_i32 v78, v77, 3, 1
    v_xor_b32 v78, v77, v78
    v_and_b32 v78, 7, v78
    v_and_b32 v79, 0x38, v77
    v_lshl_or_b32 v72, v78, 15, v79
    v_lshlrev_b32 v77, 2, v76
    ds_write_b32 v77, v72 offset:51712
    v_lshrrev_b32 v79, 1, v79
    v_lshl_add_u32 v79, v78, 5, v79
    ds_write_b32 v79, v76 offset:51968
    s_mov_b64 exec, -1
    s_waitcnt lgkmcnt(0)
    s_barrier
K2_MAPPED:
    s_mov_b64 exec, s[56:57]
    s_cbranch_execz K2_MAPD
    ds_read_b32 v64, v56 offset:51712
    s_mov_b64 exec, s[58:59]
    s_cbranch_execz K2_MAPD
    ds_read_b32 v65, v57 offset:51712
    s_mov_b64 exec, s[60:61]
    s_cbranch_execz K2_MAPD
    ds_read_b32 v66, v58 offset:51712
    s_mov_b64 exec, s[62:63]
    s_cbranch_execz K2_MAPD
    ds_read_b32 v67, v59 offset:51712
    s_mov_b64 exec, s[64:65]
    s_cbranch_execz K2_MAPD
    ds_read_b32 v68, v60 offset:51712
K2_MAPD:
    s_movk_i32 s26, 0xff
    s_waitcnt lgkmcnt(0)
    s_mov_b64 exec, s[56:57]
    s_cbranch_execz K2_COUNTED
    v_bfe_u32 v56, v80, 20, 4
    v_lshrrev_b32 v48, 8, v64
    v_lshl_add_u32 v56, v56, 2, v48
    ds_add_rtn_u32 v48, v56, v73 offset:48640
    v_bfi_b32 v80, s26, v64, v80
    s_mov_b64 exec, s[58:59]
    s_cbranch_execz K2_COUNTED
    v_bfe_u32 v57, v84, 20, 4
    v_lshrrev_b32 v49, 8, v65
    v_lshl_add_u32 v57, v57, 2, v49
    ds_add_rtn_u32 v49, v57, v73 offset:48640
    v_bfi_b32 v84, s26, v65, v84
    s_mov_b64 exec, s[60:61]
    s_cbranch_execz K2_COUNTED
    v_bfe_u32 v58, v88, 20, 4
    v_lshrrev_b32 v50, 8, v66
    v_lshl_add_u32 v58, v58, 2, v50
    ds_add_rtn_u32 v50, v58, v73 offset:48640
    v_bfi_b32 v88, s26, v66, v88
    s_mov_b64 exec, s[62:63]
    s_cbranch_execz K2_COUNTED
    v_bfe_u32 v59, v92, 20, 4
    v_lshrrev_b32 v51, 8, v67
    v_lshl_add_u32 v59, v59, 2, v51
    ds_add_rtn_u32 v51, v59, v73 offset:48640
    v_bfi_b32 v92, s26, v67, v92
    s_mov_b64 exec, s[64:65]
    s_cbranch_execz K2_COUNTED
    v_bfe_u32 v60, v96, 20, 4
    v_lshrrev_b32 v52, 8, v68
    v_lshl_add_u32 v60, v60, 2, v52
    ds_add_rtn_u32 v52, v60, v73 offset:48640
    v_bfi_b32 v96, s26, v68, v96
K2_COUNTED:
    s_mov_b64 exec, -1
    v_mov_b32 v74, 0
    s_waitcnt lgkmcnt(0)
    s_barrier
    ds_read_b128 v[144:147], v1 offset:48640
    ds_read_b32 v74, v74 offset:49664
    ds_read_b128 v[160:163], v1 offset:43520
    ds_read_b128 v[164:167], v1 offset:44544
    ds_read_b128 v[168:171], v1 offset:45568
    ds_read_b128 v[172:175], v1 offset:46592
    ds_read_b128 v[176:179], v1 offset:47616
    s_cmp_eq_u64 s[58:59], 0
    s_cbranch_scc1 K2_EAISS
    v_add_u32_dpp v152, v101, v110 quad_perm:[0,0,2,2] row_mask:0xf bank_mask:0xf
    buffer_load_dwordx4 v[224:227], v152, s[8:11], 0 offen
    v_add_u32_dpp v153, v101, v110 quad_perm:[1,1,3,3] row_mask:0xf bank_mask:0xf
    buffer_load_dwordx4 v[228:231], v153, s[8:11], 0 offen
    s_cmp_eq_u64 s[60:61], 0
    s_cbranch_scc1 K2_EAISS
    v_add_u32_dpp v152, v102, v110 quad_perm:[0,0,2,2] row_mask:0xf bank_mask:0xf
    buffer_load_dwordx4 v[232:235], v152, s[8:11], 0 offen
    v_add_u32_dpp v153, v102, v110 quad_perm:[1,1,3,3] row_mask:0xf bank_mask:0xf
    buffer_load_dwordx4 v[236:239], v153, s[8:11], 0 offen
    s_cmp_eq_u64 s[62:63], 0
    s_cbranch_scc1 K2_EAISS
    v_add_u32_dpp v152, v103, v110 quad_perm:[0,0,2,2] row_mask:0xf bank_mask:0xf
    buffer_load_dwordx4 v[240:243], v152, s[8:11], 0 offen
    v_add_u32_dpp v153, v103, v110 quad_perm:[1,1,3,3] row_mask:0xf bank_mask:0xf
    buffer_load_dwordx4 v[244:247], v153, s[8:11], 0 offen
    s_cmp_eq_u64 s[64:65], 0
    s_cbranch_scc1 K2_EAISS
    v_add_u32_dpp v152, v104, v110 quad_perm:[0,0,2,2] row_mask:0xf bank_mask:0xf
    buffer_load_dwordx4 v[248:251], v152, s[8:11], 0 offen
    v_add_u32_dpp v153, v104, v110 quad_perm:[1,1,3,3] row_mask:0xf bank_mask:0xf
    buffer_load_dwordx4 v[252:255], v153, s[8:11], 0 offen
K2_EAISS:
    s_lshl_b32 s26, s20, 3
    s_add_u32 s27, s26, 7
    s_waitcnt lgkmcnt(5)
    v_add3_u32 v75, v144, v145, v146
    v_add_u32 v75, v75, v147
    v_mov_b32 v76, v75
    v_readfirstlane_b32 s25, v74
    s_nop 1
    v_add_u32_dpp v76, v76, v76 row_shr:1 row_mask:0xf bank_mask:0xf
    s_nop 1
    v_add_u32_dpp v76, v76, v76 row_shr:2 row_mask:0xf bank_mask:0xf
    s_nop 1
    v_add_u32_dpp v76, v76, v76 row_shr:4 row_mask:0xf bank_mask:0xf
    s_nop 1
    v_add_u32_dpp v76, v76, v76 row_shr:8 row_mask:0xf bank_mask:0xf
    s_nop 1
    v_add_u32_dpp v76, v76, v76 row_bcast:15 row_mask:0xa bank_mask:0xf
    s_nop 1
    v_add_u32_dpp v76, v76, v76 row_bcast:31 row_mask:0xc bank_mask:0xf
    v_sub_u32 v148, v76, v75
    v_add_u32 v149, v148, v144
    v_add_u32 v150, v149, v145
    v_add_u32 v151, v150, v146
    ds_write_b128 v1, v[148:151] offset:50688
    v_readlane_b32 s23, v76, s27
    v_readlane_b32 s22, v148, s26
    s_mov_b64 exec, s[56:57]
    s_cbranch_execz K2_BASED
    ds_read_b32 v64, v56 offset:50688
    s_mov_b64 exec, s[58:59]
    s_cbranch_execz K2_BASED
    ds_read_b32 v65, v57 offset:50688
    s_mov_b64 exec, s[60:61]
    s_cbranch_execz K2_BASED
    ds_read_b32 v66, v58 offset:50688
    s_mov_b64 exec, s[62:63]
    s_cbranch_execz K2_BASED
    ds_read_b32 v67, v59 offset:50688
    s_mov_b64 exec, s[64:65]
    s_cbranch_execz K2_BASED
    ds_read_b32 v68, v60 offset:50688
K2_BASED:
    s_mov_b64 exec, -1
    s_sub_u32 s24, s23, s22
    s_lshl_b32 s24, s24, 4
    s_lshl_b32 s27, s22, 4
    s_add_u32 s27, s27, 119936
    v_add_u32 v3, s27, v1
    v_bfe_u32 v78, v1, 7, 2
    v_bfe_u32 v79, v1, 4, 2
    v_lshl_add_u32 v78, v78, 2, v79
    v_lshl_add_u32 v4, v78, 4, s27
    s_lshl_b32 s27, s22, 5
    s_add_u32 s27, s27, 85120
    v_lshl_add_u32 v5, v78, 5, s27
    v_lshrrev_b32 v79, 9, v1
    v_lshl_add_u32 v5, v79, 4, v5
    v_cmp_gt_u32 vcc, s24, v1
    s_mov_b32 s26, 119936
    s_waitcnt lgkmcnt(0)
    s_mov_b64 exec, s[56:57]
    s_cbranch_execz K2_SCATTERED
    v_add_u32 v64, v64, v48
    v_lshl_add_u32 v64, v64, 4, s26
    ds_write_b128 v64, v[80:83]
    v_lshlrev_b32 v105, 1, v64
    s_mov_b64 exec, s[58:59]
    s_cbranch_execz K2_SCATTERED
    v_add_u32 v65, v65, v49
    v_lshl_add_u32 v65, v65, 4, s26
    ds_write_b128 v65, v[84:87]
    v_lshlrev_b32 v106, 1, v65
    s_mov_b64 exec, s[60:61]
    s_cbranch_execz K2_SCATTERED
    v_add_u32 v66, v66, v50
    v_lshl_add_u32 v66, v66, 4, s26
    ds_write_b128 v66, v[88:91]
    v_lshlrev_b32 v107, 1, v66
    s_mov_b64 exec, s[62:63]
    s_cbranch_execz K2_SCATTERED
    v_add_u32 v67, v67, v51
    v_lshl_add_u32 v67, v67, 4, s26
    ds_write_b128 v67, v[92:95]
    v_lshlrev_b32 v108, 1, v67
    s_mov_b64 exec, s[64:65]
    s_cbranch_execz K2_SCATTERED
    v_add_u32 v68, v68, v52
    v_lshl_add_u32 v68, v68, 4, s26
    ds_write_b128 v68, v[96:99]
    v_lshlrev_b32 v109, 1, v68
K2_SCATTERED:
    s_mov_b64 exec, -1
    s_waitcnt lgkmcnt(0)
    s_barrier
    ds_read_b32 v2, v3
    s_mov_b64 exec, s[32:33]
    ds_read2_b32 v[188:189], v4 offset0:1 offset1:3
    s_mov_b64 exec, -1
    s_lshl_b32 s26, s20, 5
    v_mov_b32 v144, s26
    ds_read_b128 v[148:151], v144 offset:51968
    ds_read_b32 v146, v144 offset:51984
    s_waitcnt lgkmcnt(3)
    v_cndmask_b32 v2, 40, v2, vcc
    v_add_u32 v3, 256, v3
    v_readlane_b32 s40, v2, 0
    v_readlane_b32 s41, v2, 1
    v_readlane_b32 s42, v2, 2
    v_readlane_b32 s43, v2, 3
    v_readlane_b32 s44, v2, 4
    v_readlane_b32 s45, v2, 5
    s_and_b32 s26, s40, 0xfffc00
    buffer_load_dwordx4 v[192:195], v1, s[4:7], s26 offen
    s_and_b32 s26, s41, 0xfffc00
    buffer_load_dwordx4 v[196:199], v1, s[4:7], s26 offen
    s_and_b32 s26, s42, 0xfffc00
    buffer_load_dwordx4 v[200:203], v1, s[4:7], s26 offen
    s_and_b32 s26, s43, 0xfffc00
    buffer_load_dwordx4 v[204:207], v1, s[4:7], s26 offen
    s_and_b32 s26, s44, 0xfffc00
    buffer_load_dwordx4 v[208:211], v1, s[4:7], s26 offen
    s_and_b32 s26, s45, 0xfffc00
    buffer_load_dwordx4 v[212:215], v1, s[4:7], s26 offen
    s_waitcnt lgkmcnt(0)
    v_mfma_f32_32x32x8_bf16 v[48:63], v[188:189], v[176:177], 0
    v_mfma_f32_32x32x8_bf16 v[64:79], v[188:189], v[178:179], 0
    v_add_u32 v4, 256, v4
    v_readfirstlane_b32 s66, v148
    v_readfirstlane_b32 s67, v149
    v_readfirstlane_b32 s68, v150
    v_readfirstlane_b32 s69, v151
    v_readfirstlane_b32 s70, v146
    s_and_b32 s27, s20, 1
    s_mul_i32 s26, s27, 16400
    s_add_u32 s26, s26, 52224
    v_add_u32 v6, s26, v1
    s_nop 1
    s_mov_b64 exec, s[34:35]
    v_cvt_pk_bf16_f32 v112, v48, v64
    v_cvt_pk_bf16_f32 v114, v49, v65
    v_cvt_pk_bf16_f32 v116, v50, v66
    v_cvt_pk_bf16_f32 v118, v51, v67
    v_cvt_pk_bf16_f32 v120, v52, v68
    v_cvt_pk_bf16_f32 v122, v53, v69
    v_cvt_pk_bf16_f32 v124, v54, v70
    v_cvt_pk_bf16_f32 v126, v55, v71
    v_cvt_pk_bf16_f32 v128, v56, v72
    v_cvt_pk_bf16_f32 v130, v57, v73
    v_cvt_pk_bf16_f32 v132, v58, v74
    v_cvt_pk_bf16_f32 v134, v59, v75
    v_cvt_pk_bf16_f32 v136, v60, v76
    v_cvt_pk_bf16_f32 v138, v61, v77
    v_cvt_pk_bf16_f32 v140, v62, v78
    v_cvt_pk_bf16_f32 v142, v63, v79
    s_mov_b64 exec, s[36:37]
    v_cvt_pk_bf16_f32 v113, v48, v64
    v_cvt_pk_bf16_f32 v115, v49, v65
    v_cvt_pk_bf16_f32 v117, v50, v66
    v_cvt_pk_bf16_f32 v119, v51, v67
    v_cvt_pk_bf16_f32 v121, v52, v68
    v_cvt_pk_bf16_f32 v123, v53, v69
    v_cvt_pk_bf16_f32 v125, v54, v70
    v_cvt_pk_bf16_f32 v127, v55, v71
    v_cvt_pk_bf16_f32 v129, v56, v72
    v_cvt_pk_bf16_f32 v131, v57, v73
    v_cvt_pk_bf16_f32 v133, v58, v74
    v_cvt_pk_bf16_f32 v135, v59, v75
    v_cvt_pk_bf16_f32 v137, v60, v76
    v_cvt_pk_bf16_f32 v139, v61, v77
    v_cvt_pk_bf16_f32 v141, v62, v78
    v_cvt_pk_bf16_f32 v143, v63, v79
    s_mov_b64 exec, -1
    s_lshl_b32 s26, s2, 3
    s_add_u32 s26, s26, s20
    s_cmp_lg_u32 s26, 7
    s_cbranch_scc1 K2_FIN2
    v_lshlrev_b32 v156, 3, v1
    v_add_u32 v157, 8192, v156
    v_min_u32 v157, 15872, v157
    s_mov_b32 s26, 393216
    s_mov_b32 s27, 0
K2_ACK:
    buffer_load_dwordx2 v[152:153], v156, s[16:19], s26 offen sc1
    buffer_load_dwordx2 v[154:155], v157, s[16:19], s26 offen sc1
    s_add_u32 s27, s27, 1
    s_waitcnt vmcnt(0)
    v_cmp_eq_u64 s[74:75], s[76:77], v[152:153]
    v_cmp_eq_u64 s[38:39], s[76:77], v[154:155]
    s_and_b64 s[74:75], s[74:75], s[38:39]
    s_cmp_eq_u64 s[74:75], -1
    s_cbranch_scc1 K2_ACKED
    s_cmp_lt_u32 s27, 200000
    s_cbranch_scc1 K2_ACK
K2_ACKED:
    v_mov_b32 v156, 520192
    v_mov_b32 v157, s76
    s_mov_b64 exec, 1
    buffer_store_dword v157, v156, s[16:19], 0 offen sc1
    s_mov_b64 exec, -1
K2_FIN2:
    s_waitcnt vmcnt(6)
    s_cmp_eq_u64 s[56:57], 0
    s_cbranch_scc1 K2_EAWR
    v_add_u32_dpp v144, v105, v111 quad_perm:[0,0,2,2] row_mask:0xf bank_mask:0xf
    v_add_u32_dpp v145, v105, v111 quad_perm:[1,1,3,3] row_mask:0xf bank_mask:0xf
    ds_write_b128 v144, v[216:219]
    ds_write_b128 v145, v[220:223]
    s_cmp_eq_u64 s[58:59], 0
    s_cbranch_scc1 K2_EAWR
    v_add_u32_dpp v144, v106, v111 quad_perm:[0,0,2,2] row_mask:0xf bank_mask:0xf
    v_add_u32_dpp v145, v106, v111 quad_perm:[1,1,3,3] row_mask:0xf bank_mask:0xf
    ds_write_b128 v144, v[224:227]
    ds_write_b128 v145, v[228:231]
    s_cmp_eq_u64 s[60:61], 0
    s_cbranch_scc1 K2_EAWR
    v_add_u32_dpp v144, v107, v111 quad_perm:[0,0,2,2] row_mask:0xf bank_mask:0xf
    v_add_u32_dpp v145, v107, v111 quad_perm:[1,1,3,3] row_mask:0xf bank_mask:0xf
    ds_write_b128 v144, v[232:235]
    ds_write_b128 v145, v[236:239]
    s_cmp_eq_u64 s[62:63], 0
    s_cbranch_scc1 K2_EAWR
    v_add_u32_dpp v144, v108, v111 quad_perm:[0,0,2,2] row_mask:0xf bank_mask:0xf
    v_add_u32_dpp v145, v108, v111 quad_perm:[1,1,3,3] row_mask:0xf bank_mask:0xf
    ds_write_b128 v144, v[240:243]
    ds_write_b128 v145, v[244:247]
    s_cmp_eq_u64 s[64:65], 0
    s_cbranch_scc1 K2_EAWR
    v_add_u32_dpp v144, v109, v111 quad_perm:[0,0,2,2] row_mask:0xf bank_mask:0xf
    v_add_u32_dpp v145, v109, v111 quad_perm:[1,1,3,3] row_mask:0xf bank_mask:0xf
    ds_write_b128 v144, v[248:251]
    ds_write_b128 v145, v[252:255]
K2_EAWR:
    s_waitcnt lgkmcnt(0)
    ds_read_b128 v[224:227], v6 offset:0
    ds_read_b128 v[228:231], v6 offset:1024
    ds_read_b128 v[232:235], v6 offset:2048
    ds_read_b128 v[236:239], v6 offset:3072
    ds_read_b128 v[240:243], v6 offset:4096
    ds_read_b128 v[244:247], v6 offset:5120
    ds_read_b128 v[248:251], v6 offset:6144
    ds_read_b128 v[252:255], v6 offset:7168
    s_barrier
    s_mov_b64 exec, s[28:29]
    ds_read_b128 v[180:183], v5
    s_mov_b64 exec, s[30:31]
    ds_read_b128 v[184:187], v5
    s_mov_b64 exec, -1
    v_add_u32 v5, 512, v5
    s_cmp_eq_u32 s24, 0
    s_cbranch_scc1 K2_LOOPDONE
    s_waitcnt lgkmcnt(0)
    v_mfma_f32_32x32x16_bf16 v[80:95], v[180:183], v[160:163], 0
    v_mfma_f32_32x32x16_bf16 v[80:95], v[184:187], v[164:167], v[80:95]
    v_mfma_f32_32x32x16_bf16 v[96:111], v[180:183], v[168:171], 0
    v_mfma_f32_32x32x16_bf16 v[96:111], v[184:187], v[172:175], v[96:111]
    s_branch K2_LP0
K2_LP:
    ds_read_b32 v2, v3
    v_add_u32 v3, 256, v3
    v_mfma_f32_32x32x16_bf16 v[80:95], v[180:183], v[160:163], 0
    s_mov_b64 exec, s[34:35]
    v_cvt_pk_bf16_f32 v112, v48, v64
    v_cvt_pk_bf16_f32 v114, v49, v65
    v_cvt_pk_bf16_f32 v116, v50, v66
    v_cvt_pk_bf16_f32 v118, v51, v67
    v_cvt_pk_bf16_f32 v120, v52, v68
    v_cvt_pk_bf16_f32 v122, v53, v69
    v_cvt_pk_bf16_f32 v124, v54, v70
    v_cvt_pk_bf16_f32 v126, v55, v71
    s_mov_b64 exec, -1
    v_mfma_f32_32x32x16_bf16 v[80:95], v[184:187], v[164:167], v[80:95]
    s_mov_b64 exec, s[34:35]
    v_cvt_pk_bf16_f32 v128, v56, v72
    v_cvt_pk_bf16_f32 v130, v57, v73
    v_cvt_pk_bf16_f32 v132, v58, v74
    v_cvt_pk_bf16_f32 v134, v59, v75
    v_cvt_pk_bf16_f32 v136, v60, v76
    v_cvt_pk_bf16_f32 v138, v61, v77
    v_cvt_pk_bf16_f32 v140, v62, v78
    v_cvt_pk_bf16_f32 v142, v63, v79
    s_mov_b64 exec, -1
    v_mfma_f32_32x32x16_bf16 v[96:111], v[180:183], v[168:171], 0
    s_mov_b64 exec, s[36:37]
    v_cvt_pk_bf16_f32 v113, v48, v64
    v_cvt_pk_bf16_f32 v115, v49, v65
    v_cvt_pk_bf16_f32 v117, v50, v66
    v_cvt_pk_bf16_f32 v119, v51, v67
    v_cvt_pk_bf16_f32 v121, v52, v68
    v_cvt_pk_bf16_f32 v123, v53, v69
    v_cvt_pk_bf16_f32 v125, v54, v70
    v_cvt_pk_bf16_f32 v127, v55, v71
    s_mov_b64 exec, -1
    v_mfma_f32_32x32x16_bf16 v[96:111], v[184:187], v[172:175], v[96:111]
    s_mov_b64 exec, s[36:37]
    v_cvt_pk_bf16_f32 v129, v56, v72
    v_cvt_pk_bf16_f32 v131, v57, v73
    v_cvt_pk_bf16_f32 v133, v58, v74
    v_cvt_pk_bf16_f32 v135, v59, v75
    v_cvt_pk_bf16_f32 v137, v60, v76
    v_cvt_pk_bf16_f32 v139, v61, v77
    v_cvt_pk_bf16_f32 v141, v62, v78
    v_cvt_pk_bf16_f32 v143, v63, v79
    s_mov_b64 exec, -1
    v_cmp_gt_u32 vcc, s24, v1
    s_waitcnt lgkmcnt(0)
    s_nop 0
    v_cndmask_b32 v2, 40, v2, vcc
K2_LP0:
    s_waitcnt vmcnt(4)
    v_mfma_f32_16x16x16_bf16 v[144:147], v[112:113], v[192:193], 0
    v_mfma_f32_16x16x16_bf16 v[148:151], v[112:113], v[194:195], 0
    v_readlane_b32 s46, v2, 6
    s_and_b32 s26, s46, 0xfffc00
    buffer_load_dwordx4 v[216:219], v1, s[4:7], s26 offen
    v_mfma_f32_16x16x16_bf16 v[152:155], v[114:115], v[196:197], 0
    v_mfma_f32_16x16x16_bf16 v[156:159], v[114:115], v[198:199], 0
    v_readlane_b32 s47, v2, 7
    s_nop 0
    s_set_gpr_idx_on s40, gpr_idx(SRC2,DST)
    v_fmac_f32 v8, v144, v80
    v_fmac_f32 v9, v145, v80
    v_fmac_f32 v10, v146, v80
    v_fmac_f32 v11, v147, v80
    v_fmac_f32 v12, v148, v96
    v_fmac_f32 v13, v149, v96
    v_fmac_f32 v14, v150, v96
    v_fmac_f32 v15, v151, v96
    s_set_gpr_idx_off
    s_and_b32 s26, s47, 0xfffc00
    buffer_load_dwordx4 v[220:223], v1, s[4:7], s26 offen
    s_cmp_le_u32 s24, 128
    s_cbranch_scc1 K2_DR2
    s_waitcnt vmcnt(4)
    v_mfma_f32_16x16x16_bf16 v[144:147], v[116:117], v[200:201], 0
    v_mfma_f32_16x16x16_bf16 v[148:151], v[116:117], v[202:203], 0
    v_readlane_b32 s40, v2, 8
    s_set_gpr_idx_on s41, gpr_idx(SRC2,DST)
    v_fmac_f32 v8, v152, v81
    v_fmac_f32 v9, v153, v81
    v_fmac_f32 v10, v154, v81
    v_fmac_f32 v11, v155, v81
    v_fmac_f32 v12, v156, v97
    v_fmac_f32 v13, v157, v97
    v_fmac_f32 v14, v158, v97
    v_fmac_f32 v15, v159, v97
    s_set_gpr_idx_off
    s_and_b32 s26, s40, 0xfffc00
    buffer_load_dwordx4 v[192:195], v1, s[4:7], s26 offen
    v_mfma_f32_16x16x16_bf16 v[152:155], v[118:119], v[204:205], 0
    v_mfma_f32_16x16x16_bf16 v[156:159], v[118:119], v[206:207], 0
    v_readlane_b32 s41, v2, 9
    s_set_gpr_idx_on s42, gpr_idx(SRC2,DST)
    v_fmac_f32 v8, v144, v82
    v_fmac_f32 v9, v145, v82
    v_fmac_f32 v10, v146, v82
    v_fmac_f32 v11, v147, v82
    v_fmac_f32 v12, v148, v98
    v_fmac_f32 v13, v149, v98
    v_fmac_f32 v14, v150, v98
    v_fmac_f32 v15, v151, v98
    s_set_gpr_idx_off
    s_and_b32 s26, s41, 0xfffc00
    buffer_load_dwordx4 v[196:199], v1, s[4:7], s26 offen
    s_waitcnt vmcnt(4)
    v_mfma_f32_16x16x16_bf16 v[144:147], v[120:121], v[208:209], 0
    v_mfma_f32_16x16x16_bf16 v[148:151], v[120:121], v[210:211], 0
    v_readlane_b32 s42, v2, 10
    s_set_gpr_idx_on s43, gpr_idx(SRC2,DST)
    v_fmac_f32 v8, v152, v83
    v_fmac_f32 v9, v153, v83
    v_fmac_f32 v10, v154, v83
    v_fmac_f32 v11, v155, v83
    v_fmac_f32 v12, v156, v99
    v_fmac_f32 v13, v157, v99
    v_fmac_f32 v14, v158, v99
    v_fmac_f32 v15, v159, v99
    s_set_gpr_idx_off
    s_and_b32 s26, s42, 0xfffc00
    buffer_load_dwordx4 v[200:203], v1, s[4:7], s26 offen
    v_mfma_f32_16x16x16_bf16 v[152:155], v[122:123], v[212:213], 0
    v_mfma_f32_16x16x16_bf16 v[156:159], v[122:123], v[214:215], 0
    v_readlane_b32 s43, v2, 11
    s_set_gpr_idx_on s44, gpr_idx(SRC2,DST)
    v_fmac_f32 v8, v144, v84
    v_fmac_f32 v9, v145, v84
    v_fmac_f32 v10, v146, v84
    v_fmac_f32 v11, v147, v84
    v_fmac_f32 v12, v148, v100
    v_fmac_f32 v13, v149, v100
    v_fmac_f32 v14, v150, v100
    v_fmac_f32 v15, v151, v100
    s_set_gpr_idx_off
    s_and_b32 s26, s43, 0xfffc00
    buffer_load_dwordx4 v[204:207], v1, s[4:7], s26 offen
    s_cmp_le_u32 s24, 192
    s_cbranch_scc1 K2_DR6
    s_waitcnt vmcnt(4)
    v_mfma_f32_16x16x16_bf16 v[144:147], v[124:125], v[216:217], 0
    v_mfma_f32_16x16x16_bf16 v[148:151], v[124:125], v[218:219], 0
    v_readlane_b32 s44, v2, 12
    s_set_gpr_idx_on s45, gpr_idx(SRC2,DST)
    v_fmac_f32 v8, v152, v85
    v_fmac_f32 v9, v153, v85
    v_fmac_f32 v10, v154, v85
    v_fmac_f32 v11, v155, v85
    v_fmac_f32 v12, v156, v101
    v_fmac_f32 v13, v157, v101
    v_fmac_f32 v14, v158, v101
    v_fmac_f32 v15, v159, v101
    s_set_gpr_idx_off
    s_and_b32 s26, s44, 0xfffc00
    buffer_load_dwordx4 v[208:211], v1, s[4:7], s26 offen
    s_mov_b64 exec, s[32:33]
    ds_read2_b32 v[188:189], v4 offset0:1 offset1:3
    s_mov_b64 exec, s[28:29]
    ds_read_b128 v[180:183], v5
    s_mov_b64 exec, s[30:31]
    ds_read_b128 v[184:187], v5
    s_mov_b64 exec, -1
    v_add_u32 v4, 256, v4
    v_add_u32 v5, 512, v5
    v_mfma_f32_16x16x16_bf16 v[152:155], v[126:127], v[220:221], 0
    v_mfma_f32_16x16x16_bf16 v[156:159], v[126:127], v[222:223], 0
    v_readlane_b32 s45, v2, 13
    s_set_gpr_idx_on s46, gpr_idx(SRC2,DST)
    v_fmac_f32 v8, v144, v86
    v_fmac_f32 v9, v145, v86
    v_fmac_f32 v10, v146, v86
    v_fmac_f32 v11, v147, v86
    v_fmac_f32 v12, v148, v102
    v_fmac_f32 v13, v149, v102
    v_fmac_f32 v14, v150, v102
    v_fmac_f32 v15, v151, v102
    s_set_gpr_idx_off
    s_and_b32 s26, s45, 0xfffc00
    buffer_load_dwordx4 v[212:215], v1, s[4:7], s26 offen
    s_waitcnt vmcnt(4)
    v_mfma_f32_16x16x16_bf16 v[144:147], v[128:129], v[192:193], 0
    v_mfma_f32_16x16x16_bf16 v[148:151], v[128:129], v[194:195], 0
    v_readlane_b32 s46, v2, 14
    s_set_gpr_idx_on s47, gpr_idx(SRC2,DST)
    v_fmac_f32 v8, v152, v87
    v_fmac_f32 v9, v153, v87
    v_fmac_f32 v10, v154, v87
    v_fmac_f32 v11, v155, v87
    v_fmac_f32 v12, v156, v103
    v_fmac_f32 v13, v157, v103
    v_fmac_f32 v14, v158, v103
    v_fmac_f32 v15, v159, v103
    s_set_gpr_idx_off
    s_and_b32 s26, s46, 0xfffc00
    buffer_load_dwordx4 v[216:219], v1, s[4:7], s26 offen
    v_mfma_f32_16x16x16_bf16 v[152:155], v[130:131], v[196:197], 0
    v_mfma_f32_16x16x16_bf16 v[156:159], v[130:131], v[198:199], 0
    v_readlane_b32 s47, v2, 15
    s_set_gpr_idx_on s40, gpr_idx(SRC2,DST)
    v_fmac_f32 v8, v144, v88
    v_fmac_f32 v9, v145, v88
    v_fmac_f32 v10, v146, v88
    v_fmac_f32 v11, v147, v88
    v_fmac_f32 v12, v148, v104
    v_fmac_f32 v13, v149, v104
    v_fmac_f32 v14, v150, v104
    v_fmac_f32 v15, v151, v104
    s_set_gpr_idx_off
    s_and_b32 s26, s47, 0xfffc00
    buffer_load_dwordx4 v[220:223], v1, s[4:7], s26 offen
    s_cmp_le_u32 s24, 256
    s_cbranch_scc1 K2_DR10
    s_waitcnt vmcnt(4)
    v_mfma_f32_16x16x16_bf16 v[144:147], v[132:133], v[200:201], 0
    v_mfma_f32_16x16x16_bf16 v[148:151], v[132:133], v[202:203], 0
    v_readlane_b32 s40, v2, 16
    s_set_gpr_idx_on s41, gpr_idx(SRC2,DST)
    v_fmac_f32 v8, v152, v89
    v_fmac_f32 v9, v153, v89
    v_fmac_f32 v10, v154, v89
    v_fmac_f32 v11, v155, v89
    v_fmac_f32 v12, v156, v105
    v_fmac_f32 v13, v157, v105
    v_fmac_f32 v14, v158, v105
    v_fmac_f32 v15, v159, v105
    s_set_gpr_idx_off
    s_and_b32 s26, s40, 0xfffc00
    buffer_load_dwordx4 v[192:195], v1, s[4:7], s26 offen
    s_waitcnt lgkmcnt(0)
    v_mfma_f32_32x32x8_bf16 v[48:63], v[188:189], v[176:177], 0
    v_mfma_f32_32x32x8_bf16 v[64:79], v[188:189], v[178:179], 0
    v_mfma_f32_16x16x16_bf16 v[152:155], v[134:135], v[204:205], 0
    v_mfma_f32_16x16x16_bf16 v[156:159], v[134:135], v[206:207], 0
    v_readlane_b32 s41, v2, 17
    s_set_gpr_idx_on s42, gpr_idx(SRC2,DST)
    v_fmac_f32 v8, v144, v90
    v_fmac_f32 v9, v145, v90
    v_fmac_f32 v10, v146, v90
    v_fmac_f32 v11, v147, v90
    v_fmac_f32 v12, v148, v106
    v_fmac_f32 v13, v149, v106
    v_fmac_f32 v14, v150, v106
    v_fmac_f32 v15, v151, v106
    s_set_gpr_idx_off
    s_and_b32 s26, s41, 0xfffc00
    buffer_load_dwordx4 v[196:199], v1, s[4:7], s26 offen
    s_waitcnt vmcnt(4)
    v_mfma_f32_16x16x16_bf16 v[144:147], v[136:137], v[208:209], 0
    v_mfma_f32_16x16x16_bf16 v[148:151], v[136:137], v[210:211], 0
    v_readlane_b32 s42, v2, 18
    s_set_gpr_idx_on s43, gpr_idx(SRC2,DST)
    v_fmac_f32 v8, v152, v91
    v_fmac_f32 v9, v153, v91
    v_fmac_f32 v10, v154, v91
    v_fmac_f32 v11, v155, v91
    v_fmac_f32 v12, v156, v107
    v_fmac_f32 v13, v157, v107
    v_fmac_f32 v14, v158, v107
    v_fmac_f32 v15, v159, v107
    s_set_gpr_idx_off
    s_and_b32 s26, s42, 0xfffc00
    buffer_load_dwordx4 v[200:203], v1, s[4:7], s26 offen
    v_mfma_f32_16x16x16_bf16 v[152:155], v[138:139], v[212:213], 0
    v_mfma_f32_16x16x16_bf16 v[156:159], v[138:139], v[214:215], 0
    v_readlane_b32 s43, v2, 19
    s_set_gpr_idx_on s44, gpr_idx(SRC2,DST)
    v_fmac_f32 v8, v144, v92
    v_fmac_f32 v9, v145, v92
    v_fmac_f32 v10, v146, v92
    v_fmac_f32 v11, v147, v92
    v_fmac_f32 v12, v148, v108
    v_fmac_f32 v13, v149, v108
    v_fmac_f32 v14, v150, v108
    v_fmac_f32 v15, v151, v108
    s_set_gpr_idx_off
    s_and_b32 s26, s43, 0xfffc00
    buffer_load_dwordx4 v[204:207], v1, s[4:7], s26 offen
    s_cmp_le_u32 s24, 320
    s_cbranch_scc1 K2_DR14
    s_waitcnt vmcnt(4)
    v_mfma_f32_16x16x16_bf16 v[144:147], v[140:141], v[216:217], 0
    v_mfma_f32_16x16x16_bf16 v[148:151], v[140:141], v[218:219], 0
    v_readlane_b32 s44, v2, 20
    s_set_gpr_idx_on s45, gpr_idx(SRC2,DST)
    v_fmac_f32 v8, v152, v93
    v_fmac_f32 v9, v153, v93
    v_fmac_f32 v10, v154, v93
    v_fmac_f32 v11, v155, v93
    v_fmac_f32 v12, v156, v109
    v_fmac_f32 v13, v157, v109
    v_fmac_f32 v14, v158, v109
    v_fmac_f32 v15, v159, v109
    s_set_gpr_idx_off
    s_and_b32 s26, s44, 0xfffc00
    buffer_load_dwordx4 v[208:211], v1, s[4:7], s26 offen
    v_mfma_f32_16x16x16_bf16 v[152:155], v[142:143], v[220:221], 0
    v_mfma_f32_16x16x16_bf16 v[156:159], v[142:143], v[222:223], 0
    v_readlane_b32 s45, v2, 21
    s_set_gpr_idx_on s46, gpr_idx(SRC2,DST)
    v_fmac_f32 v8, v144, v94
    v_fmac_f32 v9, v145, v94
    v_fmac_f32 v10, v146, v94
    v_fmac_f32 v11, v147, v94
    v_fmac_f32 v12, v148, v110
    v_fmac_f32 v13, v149, v110
    v_fmac_f32 v14, v150, v110
    v_fmac_f32 v15, v151, v110
    s_set_gpr_idx_off
    s_and_b32 s26, s45, 0xfffc00
    buffer_load_dwordx4 v[212:215], v1, s[4:7], s26 offen
    s_set_gpr_idx_on s47, gpr_idx(SRC2,DST)
    v_fmac_f32 v8, v152, v95
    v_fmac_f32 v9, v153, v95
    v_fmac_f32 v10, v154, v95
    v_fmac_f32 v11, v155, v95
    v_fmac_f32 v12, v156, v111
    v_fmac_f32 v13, v157, v111
    v_fmac_f32 v14, v158, v111
    v_fmac_f32 v15, v159, v111
    s_set_gpr_idx_off
    s_sub_u32 s24, s24, 256
    s_branch K2_LP
K2_DR:
    v_mfma_f32_32x32x16_bf16 v[80:95], v[180:183], v[160:163], 0
    s_mov_b64 exec, s[34:35]
    v_cvt_pk_bf16_f32 v112, v48, v64
    v_cvt_pk_bf16_f32 v114, v49, v65
    v_cvt_pk_bf16_f32 v116, v50, v66
    v_cvt_pk_bf16_f32 v118, v51, v67
    v_cvt_pk_bf16_f32 v120, v52, v68
    v_cvt_pk_bf16_f32 v122, v53, v69
    v_cvt_pk_bf16_f32 v124, v54, v70
    v_cvt_pk_bf16_f32 v126, v55, v71
    s_mov_b64 exec, -1
    v_mfma_f32_32x32x16_bf16 v[80:95], v[184:187], v[164:167], v[80:95]
    s_mov_b64 exec, s[34:35]
    v_cvt_pk_bf16_f32 v128, v56, v72
    v_cvt_pk_bf16_f32 v130, v57, v73
    v_cvt_pk_bf16_f32 v132, v58, v74
    v_cvt_pk_bf16_f32 v134, v59, v75
    v_cvt_pk_bf16_f32 v136, v60, v76
    v_cvt_pk_bf16_f32 v138, v61, v77
    v_cvt_pk_bf16_f32 v140, v62, v78
    v_cvt_pk_bf16_f32 v142, v63, v79
    s_mov_b64 exec, -1
    v_mfma_f32_32x32x16_bf16 v[96:111], v[180:183], v[168:171], 0
    s_mov_b64 exec, s[36:37]
    v_cvt_pk_bf16_f32 v113, v48, v64
    v_cvt_pk_bf16_f32 v115, v49, v65
    v_cvt_pk_bf16_f32 v117, v50, v66
    v_cvt_pk_bf16_f32 v119, v51, v67
    v_cvt_pk_bf16_f32 v121, v52, v68
    v_cvt_pk_bf16_f32 v123, v53, v69
    v_cvt_pk_bf16_f32 v125, v54, v70
    v_cvt_pk_bf16_f32 v127, v55, v71
    s_mov_b64 exec, -1
    v_mfma_f32_32x32x16_bf16 v[96:111], v[184:187], v[172:175], v[96:111]
    s_mov_b64 exec, s[36:37]
    v_cvt_pk_bf16_f32 v129, v56, v72
    v_cvt_pk_bf16_f32 v131, v57, v73
    v_cvt_pk_bf16_f32 v133, v58, v74
    v_cvt_pk_bf16_f32 v135, v59, v75
    v_cvt_pk_bf16_f32 v137, v60, v76
    v_cvt_pk_bf16_f32 v139, v61, v77
    v_cvt_pk_bf16_f32 v141, v62, v78
    v_cvt_pk_bf16_f32 v143, v63, v79
    s_mov_b64 exec, -1
    s_waitcnt vmcnt(2)
    v_mfma_f32_16x16x16_bf16 v[144:147], v[112:113], v[192:193], 0
    v_mfma_f32_16x16x16_bf16 v[148:151], v[112:113], v[194:195], 0
    v_mfma_f32_16x16x16_bf16 v[152:155], v[114:115], v[196:197], 0
    v_mfma_f32_16x16x16_bf16 v[156:159], v[114:115], v[198:199], 0
    s_nop 5
    s_set_gpr_idx_on s40, gpr_idx(SRC2,DST)
    v_fmac_f32 v8, v144, v80
    v_fmac_f32 v9, v145, v80
    v_fmac_f32 v10, v146, v80
    v_fmac_f32 v11, v147, v80
    v_fmac_f32 v12, v148, v96
    v_fmac_f32 v13, v149, v96
    v_fmac_f32 v14, v150, v96
    v_fmac_f32 v15, v151, v96
    s_set_gpr_idx_off
    s_waitcnt vmcnt(0)
K2_DR2:
    s_waitcnt vmcnt(4)
    v_mfma_f32_16x16x16_bf16 v[144:147], v[116:117], v[200:201], 0
    v_mfma_f32_16x16x16_bf16 v[148:151], v[116:117], v[202:203], 0
    s_set_gpr_idx_on s41, gpr_idx(SRC2,DST)
    v_fmac_f32 v8, v152, v81
    v_fmac_f32 v9, v153, v81
    v_fmac_f32 v10, v154, v81
    v_fmac_f32 v11, v155, v81
    v_fmac_f32 v12, v156, v97
    v_fmac_f32 v13, v157, v97
    v_fmac_f32 v14, v158, v97
    v_fmac_f32 v15, v159, v97
    s_set_gpr_idx_off
    v_mfma_f32_16x16x16_bf16 v[152:155], v[118:119], v[204:205], 0
    v_mfma_f32_16x16x16_bf16 v[156:159], v[118:119], v[206:207], 0
    s_set_gpr_idx_on s42, gpr_idx(SRC2,DST)
    v_fmac_f32 v8, v144, v82
    v_fmac_f32 v9, v145, v82
    v_fmac_f32 v10, v146, v82
    v_fmac_f32 v11, v147, v82
    v_fmac_f32 v12, v148, v98
    v_fmac_f32 v13, v149, v98
    v_fmac_f32 v14, v150, v98
    v_fmac_f32 v15, v151, v98
    s_set_gpr_idx_off
    s_waitcnt vmcnt(2)
    v_mfma_f32_16x16x16_bf16 v[144:147], v[120:121], v[208:209], 0
    v_mfma_f32_16x16x16_bf16 v[148:151], v[120:121], v[210:211], 0
    s_set_gpr_idx_on s43, gpr_idx(SRC2,DST)
    v_fmac_f32 v8, v152, v83
    v_fmac_f32 v9, v153, v83
    v_fmac_f32 v10, v154, v83
    v_fmac_f32 v11, v155, v83
    v_fmac_f32 v12, v156, v99
    v_fmac_f32 v13, v157, v99
    v_fmac_f32 v14, v158, v99
    v_fmac_f32 v15, v159, v99
    s_set_gpr_idx_off
    s_cmp_le_u32 s24, 64
    s_cbranch_scc1 K2_LOOPDONE
    v_mfma_f32_16x16x16_bf16 v[152:155], v[122:123], v[212:213], 0
    v_mfma_f32_16x16x16_bf16 v[156:159], v[122:123], v[214:215], 0
    s_set_gpr_idx_on s44, gpr_idx(SRC2,DST)
    v_fmac_f32 v8, v144, v84
    v_fmac_f32 v9, v145, v84
    v_fmac_f32 v10, v146, v84
    v_fmac_f32 v11, v147, v84
    v_fmac_f32 v12, v148, v100
    v_fmac_f32 v13, v149, v100
    v_fmac_f32 v14, v150, v100
    v_fmac_f32 v15, v151, v100
    s_set_gpr_idx_off
    s_waitcnt vmcnt(0)
K2_DR6:
    s_waitcnt vmcnt(4)
    v_mfma_f32_16x16x16_bf16 v[144:147], v[124:125], v[216:217], 0
    v_mfma_f32_16x16x16_bf16 v[148:151], v[124:125], v[218:219], 0
    s_set_gpr_idx_on s45, gpr_idx(SRC2,DST)
    v_fmac_f32 v8, v152, v85
    v_fmac_f32 v9, v153, v85
    v_fmac_f32 v10, v154, v85
    v_fmac_f32 v11, v155, v85
    v_fmac_f32 v12, v156, v101
    v_fmac_f32 v13, v157, v101
    v_fmac_f32 v14, v158, v101
    v_fmac_f32 v15, v159, v101
    s_set_gpr_idx_off
    s_mov_b64 exec, s[32:33]
    ds_read2_b32 v[188:189], v4 offset0:1 offset1:3
    s_mov_b64 exec, s[28:29]
    ds_read_b128 v[180:183], v5
    s_mov_b64 exec, s[30:31]
    ds_read_b128 v[184:187], v5
    s_mov_b64 exec, -1
    v_add_u32 v4, 256, v4
    v_add_u32 v5, 512, v5
    v_mfma_f32_16x16x16_bf16 v[152:155], v[126:127], v[220:221], 0
    v_mfma_f32_16x16x16_bf16 v[156:159], v[126:127], v[222:223], 0
    s_set_gpr_idx_on s46, gpr_idx(SRC2,DST)
    v_fmac_f32 v8, v144, v86
    v_fmac_f32 v9, v145, v86
    v_fmac_f32 v10, v146, v86
    v_fmac_f32 v11, v147, v86
    v_fmac_f32 v12, v148, v102
    v_fmac_f32 v13, v149, v102
    v_fmac_f32 v14, v150, v102
    v_fmac_f32 v15, v151, v102
    s_set_gpr_idx_off
    s_waitcnt vmcnt(2)
    v_mfma_f32_16x16x16_bf16 v[144:147], v[128:129], v[192:193], 0
    v_mfma_f32_16x16x16_bf16 v[148:151], v[128:129], v[194:195], 0
    s_set_gpr_idx_on s47, gpr_idx(SRC2,DST)
    v_fmac_f32 v8, v152, v87
    v_fmac_f32 v9, v153, v87
    v_fmac_f32 v10, v154, v87
    v_fmac_f32 v11, v155, v87
    v_fmac_f32 v12, v156, v103
    v_fmac_f32 v13, v157, v103
    v_fmac_f32 v14, v158, v103
    v_fmac_f32 v15, v159, v103
    s_set_gpr_idx_off
    s_cmp_le_u32 s24, 128
    s_cbranch_scc1 K2_LOOPDONE
    v_mfma_f32_16x16x16_bf16 v[152:155], v[130:131], v[196:197], 0
    v_mfma_f32_16x16x16_bf16 v[156:159], v[130:131], v[198:199], 0
    s_set_gpr_idx_on s40, gpr_idx(SRC2,DST)
    v_fmac_f32 v8, v144, v88
    v_fmac_f32 v9, v145, v88
    v_fmac_f32 v10, v146, v88
    v_fmac_f32 v11, v147, v88
    v_fmac_f32 v12, v148, v104
    v_fmac_f32 v13, v149, v104
    v_fmac_f32 v14, v150, v104
    v_fmac_f32 v15, v151, v104
    s_set_gpr_idx_off
    s_waitcnt vmcnt(0)
K2_DR10:
    s_waitcnt vmcnt(4)
    v_mfma_f32_16x16x16_bf16 v[144:147], v[132:133], v[200:201], 0
    v_mfma_f32_16x16x16_bf16 v[148:151], v[132:133], v[202:203], 0
    s_set_gpr_idx_on s41, gpr_idx(SRC2,DST)
    v_fmac_f32 v8, v152, v89
    v_fmac_f32 v9, v153, v89
    v_fmac_f32 v10, v154, v89
    v_fmac_f32 v11, v155, v89
    v_fmac_f32 v12, v156, v105
    v_fmac_f32 v13, v157, v105
    v_fmac_f32 v14, v158, v105
    v_fmac_f32 v15, v159, v105
    s_set_gpr_idx_off
    s_waitcnt lgkmcnt(0)
    v_mfma_f32_32x32x8_bf16 v[48:63], v[188:189], v[176:177], 0
    v_mfma_f32_32x32x8_bf16 v[64:79], v[188:189], v[178:179], 0
    v_mfma_f32_16x16x16_bf16 v[152:155], v[134:135], v[204:205], 0
    v_mfma_f32_16x16x16_bf16 v[156:159], v[134:135], v[206:207], 0
    s_set_gpr_idx_on s42, gpr_idx(SRC2,DST)
    v_fmac_f32 v8, v144, v90
    v_fmac_f32 v9, v145, v90
    v_fmac_f32 v10, v146, v90
    v_fmac_f32 v11, v147, v90
    v_fmac_f32 v12, v148, v106
    v_fmac_f32 v13, v149, v106
    v_fmac_f32 v14, v150, v106
    v_fmac_f32 v15, v151, v106
    s_set_gpr_idx_off
    s_waitcnt vmcnt(2)
    v_mfma_f32_16x16x16_bf16 v[144:147], v[136:137], v[208:209], 0
    v_mfma_f32_16x16x16_bf16 v[148:151], v[136:137], v[210:211], 0
    s_set_gpr_idx_on s43, gpr_idx(SRC2,DST)
    v_fmac_f32 v8, v152, v91
    v_fmac_f32 v9, v153, v91
    v_fmac_f32 v10, v154, v91
    v_fmac_f32 v11, v155, v91
    v_fmac_f32 v12, v156, v107
    v_fmac_f32 v13, v157, v107
    v_fmac_f32 v14, v158, v107
    v_fmac_f32 v15, v159, v107
    s_set_gpr_idx_off
    s_cmp_le_u32 s24, 192
    s_cbranch_scc1 K2_LOOPDONE
    v_mfma_f32_16x16x16_bf16 v[152:155], v[138:139], v[212:213], 0
    v_mfma_f32_16x16x16_bf16 v[156:159], v[138:139], v[214:215], 0
    s_set_gpr_idx_on s44, gpr_idx(SRC2,DST)
    v_fmac_f32 v8, v144, v92
    v_fmac_f32 v9, v145, v92
    v_fmac_f32 v10, v146, v92
    v_fmac_f32 v11, v147, v92
    v_fmac_f32 v12, v148, v108
    v_fmac_f32 v13, v149, v108
    v_fmac_f32 v14, v150, v108
    v_fmac_f32 v15, v151, v108
    s_set_gpr_idx_off
    s_waitcnt vmcnt(0)
K2_DR14:
    s_waitcnt vmcnt(4)
    v_mfma_f32_16x16x16_bf16 v[144:147], v[140:141], v[216:217], 0
    v_mfma_f32_16x16x16_bf16 v[148:151], v[140:141], v[218:219], 0
    s_set_gpr_idx_on s45, gpr_idx(SRC2,DST)
    v_fmac_f32 v8, v152, v93
    v_fmac_f32 v9, v153, v93
    v_fmac_f32 v10, v154, v93
    v_fmac_f32 v11, v155, v93
    v_fmac_f32 v12, v156, v109
    v_fmac_f32 v13, v157, v109
    v_fmac_f32 v14, v158, v109
    v_fmac_f32 v15, v159, v109
    s_set_gpr_idx_off
    v_mfma_f32_16x16x16_bf16 v[152:155], v[142:143], v[220:221], 0
    v_mfma_f32_16x16x16_bf16 v[156:159], v[142:143], v[222:223], 0
    s_set_gpr_idx_on s46, gpr_idx(SRC2,DST)
    v_fmac_f32 v8, v144, v94
    v_fmac_f32 v9, v145, v94
    v_fmac_f32 v10, v146, v94
    v_fmac_f32 v11, v147, v94
    v_fmac_f32 v12, v148, v110
    v_fmac_f32 v13, v149, v110
    v_fmac_f32 v14, v150, v110
    v_fmac_f32 v15, v151, v110
    s_set_gpr_idx_off
    s_set_gpr_idx_on s47, gpr_idx(SRC2,DST)
    v_fmac_f32 v8, v152, v95
    v_fmac_f32 v9, v153, v95
    v_fmac_f32 v10, v154, v95
    v_fmac_f32 v11, v155, v95
    v_fmac_f32 v12, v156, v111
    v_fmac_f32 v13, v157, v111
    v_fmac_f32 v14, v158, v111
    v_fmac_f32 v15, v159, v111
    s_set_gpr_idx_off
    s_sub_u32 s24, s24, 256
    s_cmp_gt_i32 s24, 0
    s_cbranch_scc1 K2_DR
K2_LOOPDONE:
    s_waitcnt vmcnt(0) lgkmcnt(0)
    s_cmp_eq_u32 s25, 0
    s_cbranch_scc1 K2_EPI
    s_nop 7
    s_nop 3
    s_barrier
    s_branch K2_ROUND
K2_EPI:
    s_mul_i32 m0, s66, 1088
    v_cvt_pk_bf16_f32 v160, v8, v12
    v_cvt_pk_bf16_f32 v161, v9, v13
    v_cvt_pk_bf16_f32 v162, v10, v14
    v_cvt_pk_bf16_f32 v163, v11, v15
    ds_write_addtid_b32 v160 offset:0
    ds_write_addtid_b32 v161 offset:272
    ds_write_addtid_b32 v162 offset:544
    ds_write_addtid_b32 v163 offset:816
    s_mul_i32 m0, s67, 1088
    v_cvt_pk_bf16_f32 v164, v16, v20
    v_cvt_pk_bf16_f32 v165, v17, v21
    v_cvt_pk_bf16_f32 v166, v18, v22
    v_cvt_pk_bf16_f32 v167, v19, v23
    ds_write_addtid_b32 v164 offset:0
    ds_write_addtid_b32 v165 offset:272
    ds_write_addtid_b32 v166 offset:544
    ds_write_addtid_b32 v167 offset:816
    s_mul_i32 m0, s68, 1088
    v_cvt_pk_bf16_f32 v168, v24, v28
    v_cvt_pk_bf16_f32 v169, v25, v29
    v_cvt_pk_bf16_f32 v170, v26, v30
    v_cvt_pk_bf16_f32 v171, v27, v31
    ds_write_addtid_b32 v168 offset:0
    ds_write_addtid_b32 v169 offset:272
    ds_write_addtid_b32 v170 offset:544
    ds_write_addtid_b32 v171 offset:816
    s_mul_i32 m0, s69, 1088
    v_cvt_pk_bf16_f32 v172, v32, v36
    v_cvt_pk_bf16_f32 v173, v33, v37
    v_cvt_pk_bf16_f32 v174, v34, v38
    v_cvt_pk_bf16_f32 v175, v35, v39
    ds_write_addtid_b32 v172 offset:0
    ds_write_addtid_b32 v173 offset:272
    ds_write_addtid_b32 v174 offset:544
    ds_write_addtid_b32 v175 offset:816
    s_mul_i32 m0, s70, 1088
    v_cvt_pk_bf16_f32 v176, v40, v44
    v_cvt_pk_bf16_f32 v177, v41, v45
    v_cvt_pk_bf16_f32 v178, v42, v46
    v_cvt_pk_bf16_f32 v179, v43, v47
    ds_write_addtid_b32 v176 offset:0
    ds_write_addtid_b32 v177 offset:272
    ds_write_addtid_b32 v178 offset:544
    ds_write_addtid_b32 v179 offset:816
    ds_read_b128 v[192:195], v6 offset:8192
    ds_read_b128 v[196:199], v6 offset:9216
    ds_read_b128 v[200:203], v6 offset:10240
    ds_read_b128 v[204:207], v6 offset:11264
    ds_read_b128 v[208:211], v6 offset:12288
    ds_read_b128 v[212:215], v6 offset:13312
    ds_read_b128 v[216:219], v6 offset:14336
    ds_read_b128 v[220:223], v6 offset:15360
    s_and_b32 s27, s20, 1
    s_lshr_b32 s26, s20, 1
    s_mul_i32 s24, s26, 3
    s_min_u32 s24, s24, 8
    s_lshl_b32 s24, s24, 4
    v_bfe_u32 v3, v1, 4, 4
    v_lshrrev_b32 v2, 8, v1
    v_add_u32 v5, s24, v3
    v_mul_u32_u24 v5, 272, v5
    v_lshl_add_u32 v5, v2, 4, v5
    v_lshlrev_b32 v3, 3, v3
    v_lshl_add_u32 v3, v2, 10, v3
    s_mul_i32 s26, s2, 40
    s_add_u32 s22, s26, 40
    s_lshl_b32 s14, s22, 10
    s_lshl_b32 s26, s26, 10
    s_lshl_b32 s24, s24, 8
    s_add_u32 s26, s26, s24
    s_lshl_b32 s27, s27, 7
    s_add_u32 s26, s26, s27
    v_add_u32 v3, s26, v3
    s_waitcnt lgkmcnt(8)
    s_barrier
    ds_read_b128 v[80:83], v5 offset:0
    ds_read_b128 v[84:87], v5 offset:64
    ds_read_b128 v[88:91], v5 offset:128
    ds_read_b128 v[92:95], v5 offset:192
    ds_read_b128 v[96:99], v5 offset:4352
    ds_read_b128 v[100:103], v5 offset:4416
    ds_read_b128 v[104:107], v5 offset:4480
    ds_read_b128 v[108:111], v5 offset:4544
    ds_read_b128 v[8:11], v5 offset:8704
    ds_read_b128 v[12:15], v5 offset:8768
    ds_read_b128 v[16:19], v5 offset:8832
    ds_read_b128 v[20:23], v5 offset:8896
    s_waitcnt lgkmcnt(11)
    v_mfma_f32_16x16x32_bf16 v[112:115], v[80:83], v[224:227], 0
    v_mfma_f32_16x16x32_bf16 v[116:119], v[80:83], v[228:231], 0
    v_mfma_f32_16x16x32_bf16 v[120:123], v[80:83], v[232:235], 0
    v_mfma_f32_16x16x32_bf16 v[124:127], v[80:83], v[236:239], 0
    s_waitcnt lgkmcnt(10)
    v_mfma_f32_16x16x32_bf16 v[112:115], v[84:87], v[240:243], v[112:115]
    v_mfma_f32_16x16x32_bf16 v[116:119], v[84:87], v[244:247], v[116:119]
    v_mfma_f32_16x16x32_bf16 v[120:123], v[84:87], v[248:251], v[120:123]
    v_mfma_f32_16x16x32_bf16 v[124:127], v[84:87], v[252:255], v[124:127]
    s_waitcnt lgkmcnt(9)
    v_mfma_f32_16x16x32_bf16 v[112:115], v[88:91], v[192:195], v[112:115]
    v_mfma_f32_16x16x32_bf16 v[116:119], v[88:91], v[196:199], v[116:119]
    v_mfma_f32_16x16x32_bf16 v[120:123], v[88:91], v[200:203], v[120:123]
    v_mfma_f32_16x16x32_bf16 v[124:127], v[88:91], v[204:207], v[124:127]
    s_waitcnt lgkmcnt(8)
    v_mfma_f32_16x16x32_bf16 v[112:115], v[92:95], v[208:211], v[112:115]
    v_mfma_f32_16x16x32_bf16 v[116:119], v[92:95], v[212:215], v[116:119]
    v_mfma_f32_16x16x32_bf16 v[120:123], v[92:95], v[216:219], v[120:123]
    v_mfma_f32_16x16x32_bf16 v[124:127], v[92:95], v[220:223], v[124:127]
    s_waitcnt lgkmcnt(7)
    v_mfma_f32_16x16x32_bf16 v[128:131], v[96:99], v[224:227], 0
    v_mfma_f32_16x16x32_bf16 v[132:135], v[96:99], v[228:231], 0
    v_mfma_f32_16x16x32_bf16 v[136:139], v[96:99], v[232:235], 0
    v_mfma_f32_16x16x32_bf16 v[140:143], v[96:99], v[236:239], 0
    s_waitcnt lgkmcnt(6)
    v_mfma_f32_16x16x32_bf16 v[128:131], v[100:103], v[240:243], v[128:131]
    v_mfma_f32_16x16x32_bf16 v[132:135], v[100:103], v[244:247], v[132:135]
    v_mfma_f32_16x16x32_bf16 v[136:139], v[100:103], v[248:251], v[136:139]
    v_mfma_f32_16x16x32_bf16 v[140:143], v[100:103], v[252:255], v[140:143]
    v_cvt_pk_bf16_f32 v160, v112, v116
    v_cvt_pk_bf16_f32 v161, v120, v124
    buffer_store_dwordx2 v[160:161], v3, s[12:15], 0 offen offset:0 sc1
    v_cvt_pk_bf16_f32 v162, v113, v117
    v_cvt_pk_bf16_f32 v163, v121, v125
    buffer_store_dwordx2 v[162:163], v3, s[12:15], 0 offen offset:256 sc1
    v_cvt_pk_bf16_f32 v164, v114, v118
    v_cvt_pk_bf16_f32 v165, v122, v126
    buffer_store_dwordx2 v[164:165], v3, s[12:15], 0 offen offset:512 sc1
    v_cvt_pk_bf16_f32 v166, v115, v119
    v_cvt_pk_bf16_f32 v167, v123, v127
    buffer_store_dwordx2 v[166:167], v3, s[12:15], 0 offen offset:768 sc1
    v_add_u32 v3, 4096, v3
    s_waitcnt lgkmcnt(5)
    v_mfma_f32_16x16x32_bf16 v[128:131], v[104:107], v[192:195], v[128:131]
    v_mfma_f32_16x16x32_bf16 v[132:135], v[104:107], v[196:199], v[132:135]
    v_mfma_f32_16x16x32_bf16 v[136:139], v[104:107], v[200:203], v[136:139]
    v_mfma_f32_16x16x32_bf16 v[140:143], v[104:107], v[204:207], v[140:143]
    s_waitcnt lgkmcnt(4)
    v_mfma_f32_16x16x32_bf16 v[128:131], v[108:111], v[208:211], v[128:131]
    v_mfma_f32_16x16x32_bf16 v[132:135], v[108:111], v[212:215], v[132:135]
    v_mfma_f32_16x16x32_bf16 v[136:139], v[108:111], v[216:219], v[136:139]
    v_mfma_f32_16x16x32_bf16 v[140:143], v[108:111], v[220:223], v[140:143]
    s_cmp_ge_u32 s20, 4
    s_cbranch_scc1 K2_LAST1
    s_waitcnt lgkmcnt(3)
    v_mfma_f32_16x16x32_bf16 v[112:115], v[8:11], v[224:227], 0
    v_mfma_f32_16x16x32_bf16 v[116:119], v[8:11], v[228:231], 0
    v_mfma_f32_16x16x32_bf16 v[120:123], v[8:11], v[232:235], 0
    v_mfma_f32_16x16x32_bf16 v[124:127], v[8:11], v[236:239], 0
    s_waitcnt lgkmcnt(2)
    v_mfma_f32_16x16x32_bf16 v[112:115], v[12:15], v[240:243], v[112:115]
    v_mfma_f32_16x16x32_bf16 v[116:119], v[12:15], v[244:247], v[116:119]
    v_mfma_f32_16x16x32_bf16 v[120:123], v[12:15], v[248:251], v[120:123]
    v_mfma_f32_16x16x32_bf16 v[124:127], v[12:15], v[252:255], v[124:127]
    v_cvt_pk_bf16_f32 v168, v128, v132
    v_cvt_pk_bf16_f32 v169, v136, v140
    buffer_store_dwordx2 v[168:169], v3, s[12:15], 0 offen offset:0 sc1
    v_cvt_pk_bf16_f32 v170, v129, v133
    v_cvt_pk_bf16_f32 v171, v137, v141
    buffer_store_dwordx2 v[170:171], v3, s[12:15], 0 offen offset:256 sc1
    v_cvt_pk_bf16_f32 v172, v130, v134
    v_cvt_pk_bf16_f32 v173, v138, v142
    buffer_store_dwordx2 v[172:173], v3, s[12:15], 0 offen offset:512 sc1
    v_cvt_pk_bf16_f32 v174, v131, v135
    v_cvt_pk_bf16_f32 v175, v139, v143
    buffer_store_dwordx2 v[174:175], v3, s[12:15], 0 offen offset:768 sc1
    v_add_u32 v3, 4096, v3
    s_waitcnt lgkmcnt(1)
    v_mfma_f32_16x16x32_bf16 v[112:115], v[16:19], v[192:195], v[112:115]
    v_mfma_f32_16x16x32_bf16 v[116:119], v[16:19], v[196:199], v[116:119]
    v_mfma_f32_16x16x32_bf16 v[120:123], v[16:19], v[200:203], v[120:123]
    v_mfma_f32_16x16x32_bf16 v[124:127], v[16:19], v[204:207], v[124:127]
    s_waitcnt lgkmcnt(0)
    v_mfma_f32_16x16x32_bf16 v[112:115], v[20:23], v[208:211], v[112:115]
    v_mfma_f32_16x16x32_bf16 v[116:119], v[20:23], v[212:215], v[116:119]
    v_mfma_f32_16x16x32_bf16 v[120:123], v[20:23], v[216:219], v[120:123]
    v_mfma_f32_16x16x32_bf16 v[124:127], v[20:23], v[220:223], v[124:127]
    s_nop 7
    v_cvt_pk_bf16_f32 v160, v112, v116
    v_cvt_pk_bf16_f32 v161, v120, v124
    buffer_store_dwordx2 v[160:161], v3, s[12:15], 0 offen offset:0 sc1
    v_cvt_pk_bf16_f32 v162, v113, v117
    v_cvt_pk_bf16_f32 v163, v121, v125
    buffer_store_dwordx2 v[162:163], v3, s[12:15], 0 offen offset:256 sc1
    v_cvt_pk_bf16_f32 v164, v114, v118
    v_cvt_pk_bf16_f32 v165, v122, v126
    buffer_store_dwordx2 v[164:165], v3, s[12:15], 0 offen offset:512 sc1
    v_cvt_pk_bf16_f32 v166, v115, v119
    v_cvt_pk_bf16_f32 v167, v123, v127
    buffer_store_dwordx2 v[166:167], v3, s[12:15], 0 offen offset:768 sc1
    v_add_u32 v3, 4096, v3
    s_branch K2_FIN
K2_LAST1:
    s_nop 5
    v_cvt_pk_bf16_f32 v168, v128, v132
    v_cvt_pk_bf16_f32 v169, v136, v140
    buffer_store_dwordx2 v[168:169], v3, s[12:15], 0 offen offset:0 sc1
    v_cvt_pk_bf16_f32 v170, v129, v133
    v_cvt_pk_bf16_f32 v171, v137, v141
    buffer_store_dwordx2 v[170:171], v3, s[12:15], 0 offen offset:256 sc1
    v_cvt_pk_bf16_f32 v172, v130, v134
    v_cvt_pk_bf16_f32 v173, v138, v142
    buffer_store_dwordx2 v[172:173], v3, s[12:15], 0 offen offset:512 sc1
    v_cvt_pk_bf16_f32 v174, v131, v135
    v_cvt_pk_bf16_f32 v175, v139, v143
    buffer_store_dwordx2 v[174:175], v3, s[12:15], 0 offen offset:768 sc1
    v_add_u32 v3, 4096, v3
K2_FIN:
K2_END:
    s_endpgm
.section .rodata,"a"
.p2align 6
.amdhsa_kernel gather_scatter__tensor_product_equiv_mace__graph_kernel
  .amdhsa_next_free_vgpr 256
  .amdhsa_next_free_sgpr 96
  .amdhsa_accum_offset 256
  .amdhsa_group_segment_fixed_size 0
  .amdhsa_kernarg_size 88
  .amdhsa_user_sgpr_count 2
  .amdhsa_user_sgpr_kernarg_segment_ptr 1
  .amdhsa_system_sgpr_workgroup_id_x 1
  .amdhsa_float_denorm_mode_32 3
.end_amdhsa_kernel
```
